```python
import torch

def _softmax(x, axis=-1):
    return torch.softmax(x, dim=axis)
def _gelu(x):
    return torch.nn.functional.gelu(x, approximate="tanh")
def _silu(x):
    return torch.nn.functional.silu(x)
def _sigmoid(x):
    return torch.sigmoid(x)
def _layernorm(x, axis=-1, eps=1e-5):
    m = x.mean(dim=axis, keepdim=True)
    v = x.var(dim=axis, keepdim=True, unbiased=False)
    return (x - m) / torch.sqrt(v + eps)
def _scatter_add(tgt, idx, src, axis=0):
    return tgt.clone().index_add_(axis, idx, src)
def _segment_sum(src, seg, n):
    out = torch.zeros((n,) + src.shape[1:], dtype=src.dtype)
    return out.index_add_(0, seg, src)
def _pad(x, pw):
    flat = tuple(v for pair in reversed(pw) for v in pair)
    return torch.nn.functional.pad(x, flat)

kernel_name = 'standalone__layernorm_linear__sampling'

def setup_inputs():

    _w = (lambda a: (lambda t: t.to(torch.bfloat16) if t.is_floating_point() else t)(torch.as_tensor(a)))
    B, S, D = 1024, 8, 576
    return {
        "x": _w((lambda *s: torch.randn(*s, dtype=torch.bfloat16) * 0.05)(B, S, D)),
        "g": _w((lambda *s: torch.randn(*s, dtype=torch.bfloat16) * 0.05)(D) + 1.0),
        "b": _w((lambda *s: torch.randn(*s, dtype=torch.bfloat16) * 0.4)(D)),
        "w": _w((lambda *s: torch.randn(*s, dtype=torch.bfloat16) * 0.05)(D, D)),
    }

def reference(x, g, b, w):
    return (_layernorm(x, axis=-1) * g + b) @ w
```

```asm
; @launch grid=(256,1,1) block=(768,1,1) lds=158336
.amdgcn_target "amdgcn-amd-amdhsa--gfx950"
.text
.globl standalone__layernorm_linear__sampling_kernel
.p2align 8
.type standalone__layernorm_linear__sampling_kernel,@function
standalone__layernorm_linear__sampling_kernel:
    s_cmp_ge_u32 s2, 255
    s_cbranch_scc1 L_end
    v_readfirstlane_b32 s36, v0
    v_and_b32 v0, 63, v0
    s_nop 2
    s_cmp_lt_u32 s36, 704
    s_cbranch_scc1 L_nz
    v_lshlrev_b32 v10, 2, v0
    v_mov_b32 v11, 0
    v_add_u32 v10, 155776, v10
    ds_write_b32 v10, v11
    s_waitcnt lgkmcnt(0)
L_nz:
    s_load_dwordx2 s[16:17], s[0:1], 0
    s_load_dwordx2 s[20:21], s[0:1], 8
    s_load_dwordx2 s[28:29], s[0:1], 24
    s_load_dwordx2 s[60:61], s[0:1], 16
    s_load_dwordx2 s[32:33], s[0:1], 32
    s_barrier
    s_setprio 3
    s_and_b32 s3, s2, 7
    s_lshr_b32 s40, s2, 3
    s_lshl1_add_u32 s41, s3, s40
    s_sub_u32 s41, s41, 30
    s_mul_i32 s42, s3, 10
    s_cmp_ge_u32 s40, 30
    s_cselect_b32 s40, s41, s40
    s_cselect_b32 s42, 80, s42
    s_mul_i32 s39, s40, 43
    s_lshr_b32 s39, s39, 7
    s_mul_i32 s43, s39, 3
    s_sub_u32 s38, s40, s43
    s_add_u32 s37, s42, s39
    s_lshr_b32 s36, s36, 6
    s_lshr_b32 s47, s36, 3
    s_and_b32 s46, s36, 3
    s_lshr_b32 s27, s39, 2
    s_add_u32 s27, s27, s38
    s_add_u32 s54, s27, s47
    s_sub_u32 s43, s54, 3
    s_min_u32 s54, s54, s43
    s_lshl_b32 s54, s54, 7
    s_mul_i32 s40, s37, 110592
    s_mul_i32 s42, s46, 27648
    s_add_u32 s44, s40, s42
    v_and_b32 v2, 7, v0
    v_lshrrev_b32 v3, 3, v0
    v_lshlrev_b32 v4, 4, v2
    v_mul_u32_u24 v8, 1152, v3
    v_add_u32 v5, v8, v4
    v_add_u32 v6, 9216, v5
    v_add_u32 v7, 18432, v5
    s_mov_b32 s18, 9437184
    s_mov_b32 s19, 0x00020000
    s_movk_i32 s22, 1152
    s_mov_b32 s23, 0x00020000
    s_mov_b32 s30, 663552
    s_mov_b32 s31, 0x00020000
    s_bitcmp1_b32 s36, 2
    s_cbranch_scc1 P_l2
    s_sub_u32 s43, s27, 3
    s_min_u32 s43, s27, s43
    s_lshl_b32 s43, s43, 7
    s_add_u32 s43, s43, s44
    s_waitcnt lgkmcnt(0)
    buffer_load_dwordx4 v[56:59], v4, s[20:23], s54 offen
    s_add_u32 s67, s44, s54
    buffer_load_dwordx4 v[20:23], v5, s[16:19], s67 offen
    buffer_load_dwordx4 v[24:27], v6, s[16:19], s67 offen
    buffer_load_dwordx4 v[28:31], v7, s[16:19], s67 offen
    buffer_load_dwordx4 v[146:149], v8, s[16:19], s43 offen
    s_add_u32 s42, s43, 9216
    buffer_load_dwordx4 v[150:153], v8, s[16:19], s42 offen
    s_add_u32 s43, s43, 18432
    buffer_load_dwordx4 v[154:157], v8, s[16:19], s43 offen
P_l2:
    v_and_b32 v9, 16, v0
    v_lshlrev_b32 v9, 1, v9
    v_xor_b32 v8, v5, v9
    v_xor_b32 v9, 64, v8
    s_mul_i32 s41, s38, 384
    s_mul_i32 s42, s46, 18432
    s_add_u32 s45, s41, s42
    s_lshl_b32 s49, s46, 11
    s_mul_i32 s42, s47, 24576
    s_add_u32 s49, s49, s42
    s_add_u32 s49, s49, 24832
    s_and_b32 s3, s39, 3
    s_bcnt1_i32_b32 s3, s3
    s_lshl_b32 s86, s3, 7
    s_add_u32 s87, s86, 128
    s_cmp_eq_u32 s87, 384
    s_cselect_b32 s87, 0, s87
    s_add_u32 s88, s87, 128
    s_cmp_eq_u32 s88, 384
    s_cselect_b32 s88, 0, s88
    s_lshl_b32 s89, s86, 6
    s_add_u32 s89, s89, s49
    s_lshl_b32 s90, s87, 6
    s_add_u32 s90, s90, s49
    s_lshl_b32 s91, s88, 6
    s_add_u32 s91, s91, s49
    s_waitcnt lgkmcnt(0)
    s_cmp_lt_u32 s36, 4
    s_cbranch_scc1 P_l1
    s_bitcmp1_b32 s36, 2
    s_cbranch_scc0 C_a0
    v_lshlrev_b32 v1, 4, v0
    s_add_u32 s48, s37, 8160
    s_mul_i32 s48, s48, 1152
    s_mul_i32 s42, s46, 288
    v_lshlrev_b32 v10, 3, v0
    v_add_u32 v10, s42, v10
    buffer_load_dwordx2 v[146:147], v10, s[16:19], s48 offen
    buffer_load_dwordx2 v[148:149], v10, s[20:23], 0 offen
    buffer_load_dwordx4 v[158:161], off, s[16:19], s48
    s_cmp_ge_u32 s46, 2
    s_cbranch_scc1 C_a0
    s_cmp_eq_u32 s46, 1
    s_cselect_b32 s60, s60, s20
    s_cselect_b32 s61, s61, s21
    s_movk_i32 s62, 1152
    s_mov_b32 s63, 0x00020000
    s_mul_i32 s48, s46, 2080
    s_add_u32 m0, s48, 147968
    s_nop 0
    buffer_load_dwordx4 v1, s[60:63], 0 offen lds
    buffer_load_dwordx4 v1, s[60:63], 0 offen offset:1024 lds
C_a0:
    s_mul_i32 s43, s54, 576
    s_add_u32 s43, s43, s45
    s_add_u32 s42, s43, 9216
    s_add_u32 m0, s89, 0
    s_add_u32 s92, s43, s86
    buffer_load_dwordx4 v8, s[28:31], s92 offen  lds
    s_add_u32 m0, s89, 1024
    s_add_u32 s92, s42, s86
    buffer_load_dwordx4 v9, s[28:31], s92 offen  lds
    s_add_u32 m0, s90, 0
    s_add_u32 s92, s43, s87
    buffer_load_dwordx4 v8, s[28:31], s92 offen  lds
    s_add_u32 m0, s90, 1024
    s_add_u32 s92, s42, s87
    buffer_load_dwordx4 v9, s[28:31], s92 offen  lds
    s_add_u32 m0, s91, 0
    s_add_u32 s92, s43, s88
    buffer_load_dwordx4 v8, s[28:31], s92 offen  lds
    s_add_u32 m0, s91, 1024
    s_add_u32 s92, s42, s88
    buffer_load_dwordx4 v9, s[28:31], s92 offen  lds
    s_bitcmp1_b32 s36, 2
    s_cbranch_scc1 L_cons
P_l1:
    s_xor_b32 s42, s36, 4
    s_cmp_lt_u32 s36, 8
    s_cselect_b32 s36, s42, s36
    v_lshlrev_b32 v1, 4, v0
    s_mov_b32 s68, 0
    s_mov_b32 s66, 0xffff0000
    s_sub_u32 s43, s27, 3
    s_min_u32 s27, s27, s43
    s_lshl_b32 s27, s27, 7
    s_add_u32 s64, s27, 128
    s_cmp_eq_u32 s64, 384
    s_cselect_b32 s64, 0, s64
    s_add_u32 s65, s64, 128
    s_cmp_eq_u32 s65, 384
    s_cselect_b32 s65, 0, s65
    s_mov_b32 s24, 0
    s_bitcmp1_b32 s39, 0
    s_cselect_b32 s25, 2, 1
    s_mulk_i32 s25, 384
    s_sub_u32 s26, 1152, s25
    s_add_u32 s42, s24, s65
    s_add_u32 s43, s25, s27
    s_cmp_eq_u32 s47, 1
    s_cselect_b32 s55, s43, s42
    s_add_u32 s42, s25, s64
    s_add_u32 s43, s25, s65
    s_cmp_eq_u32 s47, 1
    s_cselect_b32 s56, s43, s42
    s_add_u32 s42, s26, s27
    s_add_u32 s43, s26, s64
    s_cmp_eq_u32 s47, 1
    s_cselect_b32 s57, s43, s42
    s_add_u32 s42, s26, s65
    s_add_u32 s43, s26, s65
    s_cmp_eq_u32 s47, 1
    s_cselect_b32 s58, s43, s42
    s_mov_b32 s34, 9437184
    s_mov_b32 s35, 0x00020000
    v_lshrrev_b32 v10, 2, v3
    v_sub_u32 v10, 0, v10
    v_xor_b32 v10, v10, v2
    v_and_b32 v10, 3, v10
    v_lshlrev_b32 v10, 4, v10
    v_lshl_add_u32 v10, v3, 6, v10
    v_lshrrev_b32 v11, 2, v2
    v_mul_u32_u24 v11, 6208, v11
    s_and_b32 s43, s46, 1
    s_lshl_b32 s43, s43, 5
    v_xor_b32 v10, s43, v10
    s_mul_i32 s42, s46, 1536
    s_mul_i32 s43, s47, 12416
    s_add_u32 s42, s42, s43
    v_xor_b32 v12, 32, v10
    v_add3_u32 v10, v10, v11, s42
    v_add3_u32 v11, v12, v11, s42
    v_add_u32 v12, 73984, v10
    v_add_u32 v13, 73984, v11
    s_lshl_b32 s42, s47, 4
    s_lshl_b32 s43, s46, 2
    s_add_u32 s42, s42, s43
    s_add_u32 s42, s42, 155904
    v_mov_b32 v16, s42
    v_xor_b32 v15, 16, v16
    v_add_u32 v15, 96, v15
    v_and_b32 v17, 3, v0
    v_lshlrev_b32 v17, 2, v17
    v_add_u32 v17, 155904, v17
P_noex:
    s_cmp_eq_u32 s47, 0
    s_cbranch_scc0 P_w0
    s_waitcnt vmcnt(0)
P_w0:
    s_waitcnt vmcnt(6)
    s_mov_b32 s43, 0x3e003e00
    v_dot2_f32_bf16 v60, v146, s43, 0
    v_dot2_f32_bf16 v61, v150, s43, 0
    v_dot2_f32_bf16 v62, v154, s43, 0
    v_dot2_f32_bf16 v60, v147, s43, v60
    v_dot2_f32_bf16 v61, v151, s43, v61
    v_dot2_f32_bf16 v62, v155, s43, v62
    v_dot2_f32_bf16 v60, v148, s43, v60
    v_dot2_f32_bf16 v61, v152, s43, v61
    v_dot2_f32_bf16 v62, v156, s43, v62
    v_dot2_f32_bf16 v60, v149, s43, v60
    v_dot2_f32_bf16 v61, v153, s43, v61
    v_dot2_f32_bf16 v62, v157, s43, v62
    v_lshlrev_b32 v64, 16, v56
    v_and_b32 v65, s66, v56
    v_lshlrev_b32 v66, 16, v57
    v_and_b32 v67, s66, v57
    v_lshlrev_b32 v68, 16, v58
    v_and_b32 v69, s66, v58
    v_lshlrev_b32 v70, 16, v59
    v_and_b32 v71, s66, v59
    s_cmp_eq_u32 s47, 1
    s_cselect_b64 vcc, -1, 0
    v_lshlrev_b32 v128, 16, v20
    v_and_b32 v129, s66, v20
    v_lshlrev_b32 v130, 16, v21
    v_and_b32 v131, s66, v21
    v_lshlrev_b32 v132, 16, v22
    v_and_b32 v133, s66, v22
    v_lshlrev_b32 v134, 16, v23
    v_and_b32 v135, s66, v23
    v_sub_f32 v128, v128, v60
    v_sub_f32 v129, v129, v60
    v_sub_f32 v130, v130, v60
    v_sub_f32 v131, v131, v60
    v_sub_f32 v132, v132, v60
    v_sub_f32 v133, v133, v60
    v_sub_f32 v134, v134, v60
    v_sub_f32 v135, v135, v60
    v_add_f32 v104, v128, v129
    v_mul_f32 v108, v128, v128
    v_mul_f32 v109, v129, v129
    v_add_f32 v105, v130, v131
    v_fmac_f32 v108, v130, v130
    v_fmac_f32 v109, v131, v131
    v_add_f32 v104, v104, v132
    v_add_f32 v105, v105, v133
    v_fmac_f32 v108, v132, v132
    v_fmac_f32 v109, v133, v133
    v_add_f32 v104, v104, v134
    v_add_f32 v105, v105, v135
    v_fmac_f32 v108, v134, v134
    v_fmac_f32 v109, v135, v135
    v_mul_f32 v128, v128, v64
    v_mul_f32 v129, v129, v65
    v_mul_f32 v130, v130, v66
    v_mul_f32 v131, v131, v67
    v_mul_f32 v132, v132, v68
    v_mul_f32 v133, v133, v69
    v_mul_f32 v134, v134, v70
    v_mul_f32 v135, v135, v71
    v_cvt_pk_bf16_f32 v20, v128, v129
    v_cvt_pk_bf16_f32 v21, v130, v131
    v_cvt_pk_bf16_f32 v22, v132, v133
    v_cvt_pk_bf16_f32 v23, v134, v135
    ds_write_b128 v10, v[20:23] offset:0
    v_lshlrev_b32 v136, 16, v24
    v_and_b32 v137, s66, v24
    v_lshlrev_b32 v138, 16, v25
    v_and_b32 v139, s66, v25
    v_lshlrev_b32 v140, 16, v26
    v_and_b32 v141, s66, v26
    v_lshlrev_b32 v142, 16, v27
    v_and_b32 v143, s66, v27
    v_sub_f32 v136, v136, v61
    v_sub_f32 v137, v137, v61
    v_sub_f32 v138, v138, v61
    v_sub_f32 v139, v139, v61
    v_sub_f32 v140, v140, v61
    v_sub_f32 v141, v141, v61
    v_sub_f32 v142, v142, v61
    v_sub_f32 v143, v143, v61
    v_add_f32 v112, v136, v137
    s_add_u32 s67, s44, s55
    buffer_load_dwordx4 v[32:35], v5, s[16:19], s67 offen
    v_mul_f32 v116, v136, v136
    v_mul_f32 v117, v137, v137
    v_add_f32 v113, v138, v139
    v_fmac_f32 v116, v138, v138
    v_fmac_f32 v117, v139, v139
    v_add_f32 v112, v112, v140
    v_add_f32 v113, v113, v141
    v_fmac_f32 v116, v140, v140
    v_fmac_f32 v117, v141, v141
    v_add_f32 v112, v112, v142
    v_add_f32 v113, v113, v143
    v_fmac_f32 v116, v142, v142
    v_fmac_f32 v117, v143, v143
    v_mul_f32 v136, v136, v64
    v_mul_f32 v137, v137, v65
    v_mul_f32 v138, v138, v66
    v_mul_f32 v139, v139, v67
    v_mul_f32 v140, v140, v68
    v_mul_f32 v141, v141, v69
    v_mul_f32 v142, v142, v70
    buffer_load_dwordx4 v[36:39], v6, s[16:19], s67 offen
    v_mul_f32 v143, v143, v71
    v_cvt_pk_bf16_f32 v24, v136, v137
    v_cvt_pk_bf16_f32 v25, v138, v139
    v_cvt_pk_bf16_f32 v26, v140, v141
    v_cvt_pk_bf16_f32 v27, v142, v143
    ds_write_b128 v11, v[24:27] offset:512
    v_lshlrev_b32 v128, 16, v28
    v_and_b32 v129, s66, v28
    v_lshlrev_b32 v130, 16, v29
    v_and_b32 v131, s66, v29
    v_lshlrev_b32 v132, 16, v30
    v_and_b32 v133, s66, v30
    v_lshlrev_b32 v134, 16, v31
    v_and_b32 v135, s66, v31
    v_sub_f32 v128, v128, v62
    v_sub_f32 v129, v129, v62
    v_sub_f32 v130, v130, v62
    v_sub_f32 v131, v131, v62
    v_sub_f32 v132, v132, v62
    v_sub_f32 v133, v133, v62
    buffer_load_dwordx4 v[40:43], v7, s[16:19], s67 offen
    v_sub_f32 v134, v134, v62
    v_sub_f32 v135, v135, v62
    v_add_f32 v120, v128, v129
    v_mul_f32 v124, v128, v128
    v_mul_f32 v125, v129, v129
    v_add_f32 v121, v130, v131
    v_fmac_f32 v124, v130, v130
    v_fmac_f32 v125, v131, v131
    v_add_f32 v120, v120, v132
    v_add_f32 v121, v121, v133
    v_fmac_f32 v124, v132, v132
    v_fmac_f32 v125, v133, v133
    v_add_f32 v120, v120, v134
    v_add_f32 v121, v121, v135
    v_fmac_f32 v124, v134, v134
    v_fmac_f32 v125, v135, v135
    v_mul_f32 v128, v128, v64
    v_mul_f32 v129, v129, v65
    v_mul_f32 v130, v130, v66
    v_mul_f32 v131, v131, v67
    v_mul_f32 v132, v132, v68
    v_mul_f32 v133, v133, v69
    v_mul_f32 v134, v134, v70
    v_mul_f32 v135, v135, v71
    v_cvt_pk_bf16_f32 v28, v128, v129
    v_cvt_pk_bf16_f32 v29, v130, v131
    v_cvt_pk_bf16_f32 v30, v132, v133
    v_cvt_pk_bf16_f32 v31, v134, v135
    ds_write_b128 v10, v[28:31] offset:1024
    v_mov_b32 v19, 1
    s_cbranch_vccz P_r0
    s_waitcnt vmcnt(3)
P_r0:
    ds_write_b32 v16, v19
    s_setprio 2
SP_0:
    ds_read_b32 v18, v17 offset:64
    s_waitcnt lgkmcnt(0)
    v_cmp_le_u32 vcc, 1, v18
    s_add_u32 s68, s68, 1
    s_bitcmp1_b32 s68, 18
    s_cbranch_scc1 SP_ok0
    s_cmp_eq_u64 vcc, exec
    s_cbranch_scc0 SP_0
SP_ok0:
    v_lshlrev_b32 v19, 1, v4
    v_add_u32 v19, 156032, v19
    s_lshl_b32 s43, s55, 1
    v_add_u32 v18, s43, v19
    ds_read_b128 v[72:75], v18
    ds_read_b128 v[76:79], v18 offset:16
    s_lshl_b32 s43, s56, 1
    v_add_u32 v18, s43, v19
    ds_read_b128 v[80:83], v18
    ds_read_b128 v[84:87], v18 offset:16
    s_lshl_b32 s43, s57, 1
    v_add_u32 v18, s43, v19
    ds_read_b128 v[88:91], v18
    ds_read_b128 v[92:95], v18 offset:16
    s_lshl_b32 s43, s58, 1
    v_add_u32 v18, s43, v19
    ds_read_b128 v[96:99], v18
    ds_read_b128 v[100:103], v18 offset:16
    s_waitcnt lgkmcnt(0)
    s_waitcnt vmcnt(0)
    s_mul_i32 s43, s55, 576
    s_add_u32 s43, s43, s45
    s_add_u32 s42, s43, 9216
    s_add_u32 m0, s89, 73984
    s_add_u32 s92, s43, s86
    buffer_load_dwordx4 v8, s[28:31], s92 offen  lds
    v_lshlrev_b32 v128, 16, v32
    v_and_b32 v129, s66, v32
    v_lshlrev_b32 v130, 16, v33
    v_and_b32 v131, s66, v33
    v_lshlrev_b32 v132, 16, v34
    v_and_b32 v133, s66, v34
    v_lshlrev_b32 v134, 16, v35
    v_and_b32 v135, s66, v35
    v_sub_f32 v128, v128, v60
    v_sub_f32 v129, v129, v60
    v_sub_f32 v130, v130, v60
    v_sub_f32 v131, v131, v60
    v_sub_f32 v132, v132, v60
    v_sub_f32 v133, v133, v60
    s_add_u32 m0, s89, 75008
    s_add_u32 s92, s42, s86
    buffer_load_dwordx4 v9, s[28:31], s92 offen  lds
    v_sub_f32 v134, v134, v60
    v_sub_f32 v135, v135, v60
    v_add_f32 v104, v104, v128
    v_add_f32 v105, v105, v129
    v_fmac_f32 v108, v128, v128
    v_fmac_f32 v109, v129, v129
    v_add_f32 v104, v104, v130
    v_add_f32 v105, v105, v131
    v_fmac_f32 v108, v130, v130
    v_fmac_f32 v109, v131, v131
    v_add_f32 v104, v104, v132
    v_add_f32 v105, v105, v133
    v_fmac_f32 v108, v132, v132
    v_fmac_f32 v109, v133, v133
    s_add_u32 m0, s90, 73984
    s_add_u32 s92, s43, s87
    buffer_load_dwordx4 v8, s[28:31], s92 offen  lds
    v_add_f32 v104, v104, v134
    v_add_f32 v105, v105, v135
    v_fmac_f32 v108, v134, v134
    v_fmac_f32 v109, v135, v135
    v_mul_f32 v128, v128, v72
    v_mul_f32 v129, v129, v73
    v_mul_f32 v130, v130, v74
    v_mul_f32 v131, v131, v75
    v_mul_f32 v132, v132, v76
    v_mul_f32 v133, v133, v77
    v_mul_f32 v134, v134, v78
    v_mul_f32 v135, v135, v79
    v_cvt_pk_bf16_f32 v32, v128, v129
    v_cvt_pk_bf16_f32 v33, v130, v131
    s_add_u32 m0, s90, 75008
    s_add_u32 s92, s42, s87
    buffer_load_dwordx4 v9, s[28:31], s92 offen  lds
    v_cvt_pk_bf16_f32 v34, v132, v133
    v_cvt_pk_bf16_f32 v35, v134, v135
    ds_write_b128 v12, v[32:35] offset:0
    v_lshlrev_b32 v136, 16, v36
    v_and_b32 v137, s66, v36
    v_lshlrev_b32 v138, 16, v37
    v_and_b32 v139, s66, v37
    v_lshlrev_b32 v140, 16, v38
    v_and_b32 v141, s66, v38
    v_lshlrev_b32 v142, 16, v39
    v_and_b32 v143, s66, v39
    v_sub_f32 v136, v136, v61
    v_sub_f32 v137, v137, v61
    v_sub_f32 v138, v138, v61
    s_add_u32 m0, s91, 73984
    s_add_u32 s92, s43, s88
    buffer_load_dwordx4 v8, s[28:31], s92 offen  lds
    v_sub_f32 v139, v139, v61
    v_sub_f32 v140, v140, v61
    v_sub_f32 v141, v141, v61
    v_sub_f32 v142, v142, v61
    v_sub_f32 v143, v143, v61
    v_add_f32 v112, v112, v136
    v_add_f32 v113, v113, v137
    v_fmac_f32 v116, v136, v136
    v_fmac_f32 v117, v137, v137
    v_add_f32 v112, v112, v138
    v_add_f32 v113, v113, v139
    v_fmac_f32 v116, v138, v138
    v_fmac_f32 v117, v139, v139
    v_add_f32 v112, v112, v140
    s_add_u32 m0, s91, 75008
    s_add_u32 s92, s42, s88
    buffer_load_dwordx4 v9, s[28:31], s92 offen  lds
    v_add_f32 v113, v113, v141
    v_fmac_f32 v116, v140, v140
    v_fmac_f32 v117, v141, v141
    v_add_f32 v112, v112, v142
    v_add_f32 v113, v113, v143
    v_fmac_f32 v116, v142, v142
    v_fmac_f32 v117, v143, v143
    v_mul_f32 v136, v136, v72
    v_mul_f32 v137, v137, v73
    v_mul_f32 v138, v138, v74
    v_mul_f32 v139, v139, v75
    v_mul_f32 v140, v140, v76
    v_mul_f32 v141, v141, v77
    v_mul_f32 v142, v142, v78
    s_add_u32 s67, s44, s56
    buffer_load_dwordx4 v[20:23], v5, s[16:19], s67 offen
    v_mul_f32 v143, v143, v79
    v_cvt_pk_bf16_f32 v36, v136, v137
    v_cvt_pk_bf16_f32 v37, v138, v139
    v_cvt_pk_bf16_f32 v38, v140, v141
    v_cvt_pk_bf16_f32 v39, v142, v143
    ds_write_b128 v13, v[36:39] offset:512
    v_lshlrev_b32 v128, 16, v40
    v_and_b32 v129, s66, v40
    v_lshlrev_b32 v130, 16, v41
    v_and_b32 v131, s66, v41
    v_lshlrev_b32 v132, 16, v42
    v_and_b32 v133, s66, v42
    v_lshlrev_b32 v134, 16, v43
    v_and_b32 v135, s66, v43
    buffer_load_dwordx4 v[24:27], v6, s[16:19], s67 offen
    v_sub_f32 v128, v128, v62
    v_sub_f32 v129, v129, v62
    v_sub_f32 v130, v130, v62
    v_sub_f32 v131, v131, v62
    v_sub_f32 v132, v132, v62
    v_sub_f32 v133, v133, v62
    v_sub_f32 v134, v134, v62
    v_sub_f32 v135, v135, v62
    v_add_f32 v120, v120, v128
    v_add_f32 v121, v121, v129
    v_fmac_f32 v124, v128, v128
    v_fmac_f32 v125, v129, v129
    v_add_f32 v120, v120, v130
    v_add_f32 v121, v121, v131
    buffer_load_dwordx4 v[28:31], v7, s[16:19], s67 offen
    v_fmac_f32 v124, v130, v130
    v_fmac_f32 v125, v131, v131
    v_add_f32 v120, v120, v132
    v_add_f32 v121, v121, v133
    v_fmac_f32 v124, v132, v132
    v_fmac_f32 v125, v133, v133
    v_add_f32 v120, v120, v134
    v_add_f32 v121, v121, v135
    v_fmac_f32 v124, v134, v134
    v_fmac_f32 v125, v135, v135
    v_mul_f32 v128, v128, v72
    v_mul_f32 v129, v129, v73
    v_mul_f32 v130, v130, v74
    v_mul_f32 v131, v131, v75
    v_mul_f32 v132, v132, v76
    v_mul_f32 v133, v133, v77
    v_mul_f32 v134, v134, v78
    v_mul_f32 v135, v135, v79
    v_cvt_pk_bf16_f32 v40, v128, v129
    v_cvt_pk_bf16_f32 v41, v130, v131
    v_cvt_pk_bf16_f32 v42, v132, v133
    v_cvt_pk_bf16_f32 v43, v134, v135
    ds_write_b128 v12, v[40:43] offset:1024
    v_mov_b32 v19, 2
    s_waitcnt vmcnt(3)
    ds_write_b32 v16, v19
    s_setprio 1
    s_add_u32 s43, s47, 1
SP_1:
    ds_read_b32 v18, v17 offset:32
    s_waitcnt lgkmcnt(0)
    v_cmp_le_u32 vcc, s43, v18
    s_add_u32 s68, s68, 1
    s_bitcmp1_b32 s68, 18
    s_cbranch_scc1 SP_ok1
    s_cmp_eq_u64 vcc, exec
    s_cbranch_scc0 SP_1
SP_ok1:
    s_waitcnt vmcnt(0)
    s_mul_i32 s43, s56, 576
    s_add_u32 s43, s43, s45
    s_add_u32 s42, s43, 9216
    s_add_u32 m0, s89, 0
    s_add_u32 s92, s43, s86
    buffer_load_dwordx4 v8, s[28:31], s92 offen  lds
    v_lshlrev_b32 v128, 16, v20
    v_and_b32 v129, s66, v20
    v_lshlrev_b32 v130, 16, v21
    v_and_b32 v131, s66, v21
    v_lshlrev_b32 v132, 16, v22
    v_and_b32 v133, s66, v22
    v_lshlrev_b32 v134, 16, v23
    v_and_b32 v135, s66, v23
    v_sub_f32 v128, v128, v60
    v_sub_f32 v129, v129, v60
    v_sub_f32 v130, v130, v60
    v_sub_f32 v131, v131, v60
    v_sub_f32 v132, v132, v60
    v_sub_f32 v133, v133, v60
    s_add_u32 m0, s89, 1024
    s_add_u32 s92, s42, s86
    buffer_load_dwordx4 v9, s[28:31], s92 offen  lds
    v_sub_f32 v134, v134, v60
    v_sub_f32 v135, v135, v60
    v_add_f32 v104, v104, v128
    v_add_f32 v105, v105, v129
    v_fmac_f32 v108, v128, v128
    v_fmac_f32 v109, v129, v129
    v_add_f32 v104, v104, v130
    v_add_f32 v105, v105, v131
    v_fmac_f32 v108, v130, v130
    v_fmac_f32 v109, v131, v131
    v_add_f32 v104, v104, v132
    v_add_f32 v105, v105, v133
    v_fmac_f32 v108, v132, v132
    v_fmac_f32 v109, v133, v133
    s_add_u32 m0, s90, 0
    s_add_u32 s92, s43, s87
    buffer_load_dwordx4 v8, s[28:31], s92 offen  lds
    v_add_f32 v104, v104, v134
    v_add_f32 v105, v105, v135
    v_fmac_f32 v108, v134, v134
    v_fmac_f32 v109, v135, v135
    v_mul_f32 v128, v128, v80
    v_mul_f32 v129, v129, v81
    v_mul_f32 v130, v130, v82
    v_mul_f32 v131, v131, v83
    v_mul_f32 v132, v132, v84
    v_mul_f32 v133, v133, v85
    v_mul_f32 v134, v134, v86
    v_mul_f32 v135, v135, v87
    v_cvt_pk_bf16_f32 v20, v128, v129
    v_cvt_pk_bf16_f32 v21, v130, v131
    s_add_u32 m0, s90, 1024
    s_add_u32 s92, s42, s87
    buffer_load_dwordx4 v9, s[28:31], s92 offen  lds
    v_cvt_pk_bf16_f32 v22, v132, v133
    v_cvt_pk_bf16_f32 v23, v134, v135
    ds_write_b128 v10, v[20:23] offset:0
    v_lshlrev_b32 v136, 16, v24
    v_and_b32 v137, s66, v24
    v_lshlrev_b32 v138, 16, v25
    v_and_b32 v139, s66, v25
    v_lshlrev_b32 v140, 16, v26
    v_and_b32 v141, s66, v26
    v_lshlrev_b32 v142, 16, v27
    v_and_b32 v143, s66, v27
    v_sub_f32 v136, v136, v61
    v_sub_f32 v137, v137, v61
    v_sub_f32 v138, v138, v61
    s_add_u32 m0, s91, 0
    s_add_u32 s92, s43, s88
    buffer_load_dwordx4 v8, s[28:31], s92 offen  lds
    v_sub_f32 v139, v139, v61
    v_sub_f32 v140, v140, v61
    v_sub_f32 v141, v141, v61
    v_sub_f32 v142, v142, v61
    v_sub_f32 v143, v143, v61
    v_add_f32 v112, v112, v136
    v_add_f32 v113, v113, v137
    v_fmac_f32 v116, v136, v136
    v_fmac_f32 v117, v137, v137
    v_add_f32 v112, v112, v138
    v_add_f32 v113, v113, v139
    v_fmac_f32 v116, v138, v138
    v_fmac_f32 v117, v139, v139
    v_add_f32 v112, v112, v140
    s_add_u32 m0, s91, 1024
    s_add_u32 s92, s42, s88
    buffer_load_dwordx4 v9, s[28:31], s92 offen  lds
    v_add_f32 v113, v113, v141
    v_fmac_f32 v116, v140, v140
    v_fmac_f32 v117, v141, v141
    v_add_f32 v112, v112, v142
    v_add_f32 v113, v113, v143
    v_fmac_f32 v116, v142, v142
    v_fmac_f32 v117, v143, v143
    v_mul_f32 v136, v136, v80
    v_mul_f32 v137, v137, v81
    v_mul_f32 v138, v138, v82
    v_mul_f32 v139, v139, v83
    v_mul_f32 v140, v140, v84
    v_mul_f32 v141, v141, v85
    v_mul_f32 v142, v142, v86
    s_add_u32 s67, s44, s57
    buffer_load_dwordx4 v[32:35], v5, s[16:19], s67 offen
    v_mul_f32 v143, v143, v87
    v_cvt_pk_bf16_f32 v24, v136, v137
    v_cvt_pk_bf16_f32 v25, v138, v139
    v_cvt_pk_bf16_f32 v26, v140, v141
    v_cvt_pk_bf16_f32 v27, v142, v143
    ds_write_b128 v11, v[24:27] offset:512
    v_lshlrev_b32 v128, 16, v28
    v_and_b32 v129, s66, v28
    v_lshlrev_b32 v130, 16, v29
    v_and_b32 v131, s66, v29
    v_lshlrev_b32 v132, 16, v30
    v_and_b32 v133, s66, v30
    v_lshlrev_b32 v134, 16, v31
    v_and_b32 v135, s66, v31
    buffer_load_dwordx4 v[36:39], v6, s[16:19], s67 offen
    v_sub_f32 v128, v128, v62
    v_sub_f32 v129, v129, v62
    v_sub_f32 v130, v130, v62
    v_sub_f32 v131, v131, v62
    v_sub_f32 v132, v132, v62
    v_sub_f32 v133, v133, v62
    v_sub_f32 v134, v134, v62
    v_sub_f32 v135, v135, v62
    v_add_f32 v120, v120, v128
    v_add_f32 v121, v121, v129
    v_fmac_f32 v124, v128, v128
    v_fmac_f32 v125, v129, v129
    v_add_f32 v120, v120, v130
    v_add_f32 v121, v121, v131
    buffer_load_dwordx4 v[40:43], v7, s[16:19], s67 offen
    v_fmac_f32 v124, v130, v130
    v_fmac_f32 v125, v131, v131
    v_add_f32 v120, v120, v132
    v_add_f32 v121, v121, v133
    v_fmac_f32 v124, v132, v132
    v_fmac_f32 v125, v133, v133
    v_add_f32 v120, v120, v134
    v_add_f32 v121, v121, v135
    v_fmac_f32 v124, v134, v134
    v_fmac_f32 v125, v135, v135
    v_mul_f32 v128, v128, v80
    v_mul_f32 v129, v129, v81
    v_mul_f32 v130, v130, v82
    v_mul_f32 v131, v131, v83
    v_mul_f32 v132, v132, v84
    v_mul_f32 v133, v133, v85
    v_mul_f32 v134, v134, v86
    v_mul_f32 v135, v135, v87
    v_cvt_pk_bf16_f32 v28, v128, v129
    v_cvt_pk_bf16_f32 v29, v130, v131
    v_cvt_pk_bf16_f32 v30, v132, v133
    v_cvt_pk_bf16_f32 v31, v134, v135
    ds_write_b128 v10, v[28:31] offset:1024
    v_mov_b32 v19, 3
    s_waitcnt vmcnt(3)
    ds_write_b32 v16, v19
    s_setprio 0
    s_add_u32 s43, s47, 3
SP_2:
    ds_read_b32 v18, v17 offset:32
    s_waitcnt lgkmcnt(0)
    v_cmp_le_u32 vcc, s43, v18
    s_add_u32 s68, s68, 1
    s_bitcmp1_b32 s68, 18
    s_cbranch_scc1 SP_ok2
    s_cmp_eq_u64 vcc, exec
    s_cbranch_scc0 SP_2
SP_ok2:
    s_waitcnt vmcnt(0)
    s_mul_i32 s43, s57, 576
    s_add_u32 s43, s43, s45
    s_add_u32 s42, s43, 9216
    s_add_u32 m0, s89, 73984
    s_add_u32 s92, s43, s86
    buffer_load_dwordx4 v8, s[28:31], s92 offen  lds
    v_lshlrev_b32 v128, 16, v32
    v_and_b32 v129, s66, v32
    v_lshlrev_b32 v130, 16, v33
    v_and_b32 v131, s66, v33
    v_lshlrev_b32 v132, 16, v34
    v_and_b32 v133, s66, v34
    v_lshlrev_b32 v134, 16, v35
    v_and_b32 v135, s66, v35
    v_sub_f32 v128, v128, v60
    v_sub_f32 v129, v129, v60
    v_sub_f32 v130, v130, v60
    v_sub_f32 v131, v131, v60
    v_sub_f32 v132, v132, v60
    v_sub_f32 v133, v133, v60
    v_sub_f32 v134, v134, v60
    v_sub_f32 v135, v135, v60
    v_add_f32 v104, v104, v128
    v_add_f32 v105, v105, v129
    v_fmac_f32 v108, v128, v128
    v_fmac_f32 v109, v129, v129
    v_add_f32 v104, v104, v130
    s_add_u32 m0, s89, 75008
    s_add_u32 s92, s42, s86
    buffer_load_dwordx4 v9, s[28:31], s92 offen  lds
    v_add_f32 v105, v105, v131
    v_fmac_f32 v108, v130, v130
    v_fmac_f32 v109, v131, v131
    v_add_f32 v104, v104, v132
    v_add_f32 v105, v105, v133
    v_fmac_f32 v108, v132, v132
    v_fmac_f32 v109, v133, v133
    v_add_f32 v104, v104, v134
    v_add_f32 v105, v105, v135
    v_fmac_f32 v108, v134, v134
    v_fmac_f32 v109, v135, v135
    v_mul_f32 v128, v128, v88
    v_mul_f32 v129, v129, v89
    v_mul_f32 v130, v130, v90
    v_mul_f32 v131, v131, v91
    v_mul_f32 v132, v132, v92
    v_mul_f32 v133, v133, v93
    v_mul_f32 v134, v134, v94
    v_mul_f32 v135, v135, v95
    v_cvt_pk_bf16_f32 v32, v128, v129
    v_cvt_pk_bf16_f32 v33, v130, v131
    s_add_u32 m0, s90, 73984
    s_add_u32 s92, s43, s87
    buffer_load_dwordx4 v8, s[28:31], s92 offen  lds
    v_cvt_pk_bf16_f32 v34, v132, v133
    v_cvt_pk_bf16_f32 v35, v134, v135
    ds_write_b128 v12, v[32:35] offset:0
    v_lshlrev_b32 v136, 16, v36
    v_and_b32 v137, s66, v36
    v_lshlrev_b32 v138, 16, v37
    v_and_b32 v139, s66, v37
    v_lshlrev_b32 v140, 16, v38
    v_and_b32 v141, s66, v38
    v_lshlrev_b32 v142, 16, v39
    v_and_b32 v143, s66, v39
    v_sub_f32 v136, v136, v61
    v_sub_f32 v137, v137, v61
    v_sub_f32 v138, v138, v61
    v_sub_f32 v139, v139, v61
    v_sub_f32 v140, v140, v61
    v_sub_f32 v141, v141, v61
    v_sub_f32 v142, v142, v61
    v_sub_f32 v143, v143, v61
    v_add_f32 v112, v112, v136
    v_add_f32 v113, v113, v137
    s_add_u32 m0, s90, 75008
    s_add_u32 s92, s42, s87
    buffer_load_dwordx4 v9, s[28:31], s92 offen  lds
    v_fmac_f32 v116, v136, v136
    v_fmac_f32 v117, v137, v137
    v_add_f32 v112, v112, v138
    v_add_f32 v113, v113, v139
    v_fmac_f32 v116, v138, v138
    v_fmac_f32 v117, v139, v139
    v_add_f32 v112, v112, v140
    v_add_f32 v113, v113, v141
    v_fmac_f32 v116, v140, v140
    v_fmac_f32 v117, v141, v141
    v_add_f32 v112, v112, v142
    v_add_f32 v113, v113, v143
    v_fmac_f32 v116, v142, v142
    v_fmac_f32 v117, v143, v143
    v_mul_f32 v136, v136, v88
    v_mul_f32 v137, v137, v89
    v_mul_f32 v138, v138, v90
    v_mul_f32 v139, v139, v91
    v_mul_f32 v140, v140, v92
    v_mul_f32 v141, v141, v93
    v_mul_f32 v142, v142, v94
    s_add_u32 m0, s91, 73984
    s_add_u32 s92, s43, s88
    buffer_load_dwordx4 v8, s[28:31], s92 offen  lds
    v_mul_f32 v143, v143, v95
    v_cvt_pk_bf16_f32 v36, v136, v137
    v_cvt_pk_bf16_f32 v37, v138, v139
    v_cvt_pk_bf16_f32 v38, v140, v141
    v_cvt_pk_bf16_f32 v39, v142, v143
    ds_write_b128 v13, v[36:39] offset:512
    v_lshlrev_b32 v128, 16, v40
    v_and_b32 v129, s66, v40
    v_lshlrev_b32 v130, 16, v41
    v_and_b32 v131, s66, v41
    v_lshlrev_b32 v132, 16, v42
    v_and_b32 v133, s66, v42
    v_lshlrev_b32 v134, 16, v43
    v_and_b32 v135, s66, v43
    v_sub_f32 v128, v128, v62
    v_sub_f32 v129, v129, v62
    v_sub_f32 v130, v130, v62
    v_sub_f32 v131, v131, v62
    v_sub_f32 v132, v132, v62
    v_sub_f32 v133, v133, v62
    v_sub_f32 v134, v134, v62
    s_add_u32 m0, s91, 75008
    s_add_u32 s92, s42, s88
    buffer_load_dwordx4 v9, s[28:31], s92 offen  lds
    v_sub_f32 v135, v135, v62
    v_add_f32 v120, v120, v128
    v_add_f32 v121, v121, v129
    v_fmac_f32 v124, v128, v128
    v_fmac_f32 v125, v129, v129
    v_add_f32 v120, v120, v130
    v_add_f32 v121, v121, v131
    v_fmac_f32 v124, v130, v130
    v_fmac_f32 v125, v131, v131
    v_add_f32 v120, v120, v132
    v_add_f32 v121, v121, v133
    v_fmac_f32 v124, v132, v132
    v_fmac_f32 v125, v133, v133
    v_add_f32 v120, v120, v134
    v_add_f32 v121, v121, v135
    v_fmac_f32 v124, v134, v134
    v_fmac_f32 v125, v135, v135
    v_mul_f32 v128, v128, v88
    v_mul_f32 v129, v129, v89
    v_mul_f32 v130, v130, v90
    v_mul_f32 v131, v131, v91
    v_mul_f32 v132, v132, v92
    v_mul_f32 v133, v133, v93
    v_mul_f32 v134, v134, v94
    v_mul_f32 v135, v135, v95
    v_cvt_pk_bf16_f32 v40, v128, v129
    v_cvt_pk_bf16_f32 v41, v130, v131
    v_cvt_pk_bf16_f32 v42, v132, v133
    v_cvt_pk_bf16_f32 v43, v134, v135
    ds_write_b128 v12, v[40:43] offset:1024
    v_mov_b32 v19, 4
    s_waitcnt vmcnt(0)
    ds_write_b32 v16, v19
    s_cmp_eq_u32 s47, 1
    s_cbranch_scc1 P_skipx4
    s_add_u32 s67, s44, s58
    buffer_load_dwordx4 v[20:23], v5, s[16:19], s67 offen
    buffer_load_dwordx4 v[24:27], v6, s[16:19], s67 offen
    buffer_load_dwordx4 v[28:31], v7, s[16:19], s67 offen
P_skipx4:
    s_cmp_eq_u32 s47, 1
    s_cbranch_scc1 P_odd_done
    s_add_u32 s43, s47, 5
SP_3:
    ds_read_b32 v18, v17 offset:32
    s_waitcnt lgkmcnt(0)
    v_cmp_le_u32 vcc, s43, v18
    s_add_u32 s68, s68, 1
    s_bitcmp1_b32 s68, 18
    s_cbranch_scc1 SP_ok3
    s_cmp_eq_u64 vcc, exec
    s_cbranch_scc0 SP_3
SP_ok3:
    s_waitcnt vmcnt(0)
    s_mul_i32 s43, s58, 576
    s_add_u32 s43, s43, s45
    s_add_u32 s42, s43, 9216
    s_add_u32 m0, s89, 0
    s_add_u32 s92, s43, s86
    buffer_load_dwordx4 v8, s[28:31], s92 offen  lds
    v_lshlrev_b32 v128, 16, v20
    v_and_b32 v129, s66, v20
    v_lshlrev_b32 v130, 16, v21
    v_and_b32 v131, s66, v21
    v_lshlrev_b32 v132, 16, v22
    v_and_b32 v133, s66, v22
    v_lshlrev_b32 v134, 16, v23
    v_and_b32 v135, s66, v23
    v_sub_f32 v128, v128, v60
    v_sub_f32 v129, v129, v60
    v_sub_f32 v130, v130, v60
    v_sub_f32 v131, v131, v60
    v_sub_f32 v132, v132, v60
    v_sub_f32 v133, v133, v60
    v_sub_f32 v134, v134, v60
    v_sub_f32 v135, v135, v60
    v_add_f32 v104, v104, v128
    v_add_f32 v105, v105, v129
    v_fmac_f32 v108, v128, v128
    v_fmac_f32 v109, v129, v129
    v_add_f32 v104, v104, v130
    s_add_u32 m0, s89, 1024
    s_add_u32 s92, s42, s86
    buffer_load_dwordx4 v9, s[28:31], s92 offen  lds
    v_add_f32 v105, v105, v131
    v_fmac_f32 v108, v130, v130
    v_fmac_f32 v109, v131, v131
    v_add_f32 v104, v104, v132
    v_add_f32 v105, v105, v133
    v_fmac_f32 v108, v132, v132
    v_fmac_f32 v109, v133, v133
    v_add_f32 v104, v104, v134
    v_add_f32 v105, v105, v135
    v_fmac_f32 v108, v134, v134
    v_fmac_f32 v109, v135, v135
    v_mul_f32 v128, v128, v96
    v_mul_f32 v129, v129, v97
    v_mul_f32 v130, v130, v98
    v_mul_f32 v131, v131, v99
    v_mul_f32 v132, v132, v100
    v_mul_f32 v133, v133, v101
    v_mul_f32 v134, v134, v102
    v_mul_f32 v135, v135, v103
    v_cvt_pk_bf16_f32 v20, v128, v129
    v_cvt_pk_bf16_f32 v21, v130, v131
    s_add_u32 m0, s90, 0
    s_add_u32 s92, s43, s87
    buffer_load_dwordx4 v8, s[28:31], s92 offen  lds
    v_cvt_pk_bf16_f32 v22, v132, v133
    v_cvt_pk_bf16_f32 v23, v134, v135
    ds_write_b128 v10, v[20:23] offset:0
    v_lshlrev_b32 v136, 16, v24
    v_and_b32 v137, s66, v24
    v_lshlrev_b32 v138, 16, v25
    v_and_b32 v139, s66, v25
    v_lshlrev_b32 v140, 16, v26
    v_and_b32 v141, s66, v26
    v_lshlrev_b32 v142, 16, v27
    v_and_b32 v143, s66, v27
    v_sub_f32 v136, v136, v61
    v_sub_f32 v137, v137, v61
    v_sub_f32 v138, v138, v61
    v_sub_f32 v139, v139, v61
    v_sub_f32 v140, v140, v61
    v_sub_f32 v141, v141, v61
    v_sub_f32 v142, v142, v61
    v_sub_f32 v143, v143, v61
    v_add_f32 v112, v112, v136
    v_add_f32 v113, v113, v137
    s_add_u32 m0, s90, 1024
    s_add_u32 s92, s42, s87
    buffer_load_dwordx4 v9, s[28:31], s92 offen  lds
    v_fmac_f32 v116, v136, v136
    v_fmac_f32 v117, v137, v137
    v_add_f32 v112, v112, v138
    v_add_f32 v113, v113, v139
    v_fmac_f32 v116, v138, v138
    v_fmac_f32 v117, v139, v139
    v_add_f32 v112, v112, v140
    v_add_f32 v113, v113, v141
    v_fmac_f32 v116, v140, v140
    v_fmac_f32 v117, v141, v141
    v_add_f32 v112, v112, v142
    v_add_f32 v113, v113, v143
    v_fmac_f32 v116, v142, v142
    v_fmac_f32 v117, v143, v143
    v_mul_f32 v136, v136, v96
    v_mul_f32 v137, v137, v97
    v_mul_f32 v138, v138, v98
    v_mul_f32 v139, v139, v99
    v_mul_f32 v140, v140, v100
    v_mul_f32 v141, v141, v101
    v_mul_f32 v142, v142, v102
    s_add_u32 m0, s91, 0
    s_add_u32 s92, s43, s88
    buffer_load_dwordx4 v8, s[28:31], s92 offen  lds
    v_mul_f32 v143, v143, v103
    v_cvt_pk_bf16_f32 v24, v136, v137
    v_cvt_pk_bf16_f32 v25, v138, v139
    v_cvt_pk_bf16_f32 v26, v140, v141
    v_cvt_pk_bf16_f32 v27, v142, v143
    ds_write_b128 v11, v[24:27] offset:512
    v_lshlrev_b32 v128, 16, v28
    v_and_b32 v129, s66, v28
    v_lshlrev_b32 v130, 16, v29
    v_and_b32 v131, s66, v29
    v_lshlrev_b32 v132, 16, v30
    v_and_b32 v133, s66, v30
    v_lshlrev_b32 v134, 16, v31
    v_and_b32 v135, s66, v31
    v_sub_f32 v128, v128, v62
    v_sub_f32 v129, v129, v62
    v_sub_f32 v130, v130, v62
    v_sub_f32 v131, v131, v62
    v_sub_f32 v132, v132, v62
    v_sub_f32 v133, v133, v62
    v_sub_f32 v134, v134, v62
    s_add_u32 m0, s91, 1024
    s_add_u32 s92, s42, s88
    buffer_load_dwordx4 v9, s[28:31], s92 offen  lds
    v_sub_f32 v135, v135, v62
    v_add_f32 v120, v120, v128
    v_add_f32 v121, v121, v129
    v_fmac_f32 v124, v128, v128
    v_fmac_f32 v125, v129, v129
    v_add_f32 v120, v120, v130
    v_add_f32 v121, v121, v131
    v_fmac_f32 v124, v130, v130
    v_fmac_f32 v125, v131, v131
    v_add_f32 v120, v120, v132
    v_add_f32 v121, v121, v133
    v_fmac_f32 v124, v132, v132
    v_fmac_f32 v125, v133, v133
    v_add_f32 v120, v120, v134
    v_add_f32 v121, v121, v135
    v_fmac_f32 v124, v134, v134
    v_fmac_f32 v125, v135, v135
    v_mul_f32 v128, v128, v96
    v_mul_f32 v129, v129, v97
    v_mul_f32 v130, v130, v98
    v_mul_f32 v131, v131, v99
    v_mul_f32 v132, v132, v100
    v_mul_f32 v133, v133, v101
    v_mul_f32 v134, v134, v102
    v_mul_f32 v135, v135, v103
    v_cvt_pk_bf16_f32 v28, v128, v129
    v_cvt_pk_bf16_f32 v29, v130, v131
    v_cvt_pk_bf16_f32 v30, v132, v133
    v_cvt_pk_bf16_f32 v31, v134, v135
    ds_write_b128 v10, v[28:31] offset:1024
    v_mov_b32 v19, 5
    s_waitcnt vmcnt(0)
    ds_write_b32 v16, v19
    s_setprio 3
    s_nop 3
    v_add_f32 v128, v104, v105
    v_add_f32 v129, v108, v109
    v_add_f32 v130, v112, v113
    v_add_f32 v131, v116, v117
    v_add_f32 v132, v120, v121
    v_add_f32 v133, v124, v125
    s_nop 1
    v_add_f32_dpp v136, v128, v128 quad_perm:[1,0,3,2] row_mask:0xf bank_mask:0xf
    v_add_f32_dpp v137, v129, v129 quad_perm:[1,0,3,2] row_mask:0xf bank_mask:0xf
    v_add_f32_dpp v138, v130, v130 quad_perm:[1,0,3,2] row_mask:0xf bank_mask:0xf
    v_add_f32_dpp v139, v131, v131 quad_perm:[1,0,3,2] row_mask:0xf bank_mask:0xf
    v_add_f32_dpp v140, v132, v132 quad_perm:[1,0,3,2] row_mask:0xf bank_mask:0xf
    v_add_f32_dpp v141, v133, v133 quad_perm:[1,0,3,2] row_mask:0xf bank_mask:0xf
    s_nop 1
    v_add_f32_dpp v128, v136, v136 quad_perm:[2,3,0,1] row_mask:0xf bank_mask:0xf
    v_add_f32_dpp v129, v137, v137 quad_perm:[2,3,0,1] row_mask:0xf bank_mask:0xf
    v_add_f32_dpp v130, v138, v138 quad_perm:[2,3,0,1] row_mask:0xf bank_mask:0xf
    v_add_f32_dpp v131, v139, v139 quad_perm:[2,3,0,1] row_mask:0xf bank_mask:0xf
    v_add_f32_dpp v132, v140, v140 quad_perm:[2,3,0,1] row_mask:0xf bank_mask:0xf
    v_add_f32_dpp v133, v141, v141 quad_perm:[2,3,0,1] row_mask:0xf bank_mask:0xf
    s_nop 1
    v_add_f32_dpp v136, v128, v128 row_half_mirror row_mask:0xf bank_mask:0xf
    v_add_f32_dpp v137, v129, v129 row_half_mirror row_mask:0xf bank_mask:0xf
    v_add_f32_dpp v138, v130, v130 row_half_mirror row_mask:0xf bank_mask:0xf
    v_add_f32_dpp v139, v131, v131 row_half_mirror row_mask:0xf bank_mask:0xf
    v_add_f32_dpp v140, v132, v132 row_half_mirror row_mask:0xf bank_mask:0xf
    v_add_f32_dpp v141, v133, v133 row_half_mirror row_mask:0xf bank_mask:0xf
    s_mul_i32 s42, s46, 192
    s_add_u32 s42, s42, 154208
    v_lshlrev_b32 v14, 3, v3
    v_add_u32 v14, s42, v14
    s_lshl_b32 s42, s46, 2
    s_add_u32 s42, s42, 155952
    v_mov_b32 v15, s42
SP_4:
    ds_read_b32 v18, v15 offset:0
    s_waitcnt lgkmcnt(0)
    v_cmp_le_u32 vcc, 1, v18
    s_add_u32 s68, s68, 1
    s_bitcmp1_b32 s68, 18
    s_cbranch_scc1 SP_ok4
    s_cmp_eq_u64 vcc, exec
    s_cbranch_scc0 SP_4
SP_ok4:
    ds_read_b64 v[128:129], v14 offset:896
    ds_read_b64 v[130:131], v14 offset:960
    ds_read_b64 v[132:133], v14 offset:1024
    s_waitcnt lgkmcnt(0)
    v_add_f32 v136, v136, v128
    v_add_f32 v137, v137, v129
    v_add_f32 v138, v138, v130
    v_add_f32 v139, v139, v131
    v_add_f32 v140, v140, v132
    v_add_f32 v141, v141, v133
    v_cmp_eq_u32 s[76:77], 1, v2
    v_cmp_eq_u32 s[78:79], 2, v2
    v_cmp_gt_u32 s[80:81], 3, v2
    v_lshl_add_u32 v14, v2, 6, v14
    v_cndmask_b32 v136, v136, v138, s[76:77]
    v_cndmask_b32 v137, v137, v139, s[76:77]
    v_cndmask_b32 v136, v136, v140, s[78:79]
    v_cndmask_b32 v137, v137, v141, s[78:79]
    v_cndmask_b32 v60, v60, v61, s[76:77]
    v_cndmask_b32 v60, v60, v62, s[78:79]
    v_mul_f32 v136, 0x3ae38e39, v136
    v_mul_f32 v137, 0x3ae38e39, v137
    v_fma_f32 v137, -v136, v136, v137
    v_max_f32 v137, 0, v137
    v_add_f32 v136, v136, v60
    v_cvt_pk_bf16_f32 v128, v136, v137
    v_lshlrev_b32 v136, 16, v128
    v_sub_f32 v136, v60, v136
    v_and_b32 v137, 0xffff0000, v128
    v_add_f32 v137, 0x3727c5ac, v137
    v_cvt_pk_bf16_f32 v128, v137, v137
    v_lshlrev_b32 v137, 16, v128
    v_sqrt_f32 v137, v137
    s_nop 0
    v_cvt_pk_bf16_f32 v128, v137, v137
    v_lshlrev_b32 v137, 16, v128
    v_rcp_f32 v137, v137
    s_nop 0
    v_mul_f32 v136, v136, v137
    s_mov_b64 exec, s[80:81]
    ds_write_b64 v14, v[136:137]
    s_mov_b64 exec, -1
    v_mov_b32 v19, 5
    ds_write_b32 v16, v19 offset:16
    s_branch L_store
P_odd_done:
    s_setprio 3
    s_nop 3
    v_add_f32 v128, v104, v105
    v_add_f32 v129, v108, v109
    v_add_f32 v130, v112, v113
    v_add_f32 v131, v116, v117
    v_add_f32 v132, v120, v121
    v_add_f32 v133, v124, v125
    s_nop 1
    v_add_f32_dpp v136, v128, v128 quad_perm:[1,0,3,2] row_mask:0xf bank_mask:0xf
    v_add_f32_dpp v137, v129, v129 quad_perm:[1,0,3,2] row_mask:0xf bank_mask:0xf
    v_add_f32_dpp v138, v130, v130 quad_perm:[1,0,3,2] row_mask:0xf bank_mask:0xf
    v_add_f32_dpp v139, v131, v131 quad_perm:[1,0,3,2] row_mask:0xf bank_mask:0xf
    v_add_f32_dpp v140, v132, v132 quad_perm:[1,0,3,2] row_mask:0xf bank_mask:0xf
    v_add_f32_dpp v141, v133, v133 quad_perm:[1,0,3,2] row_mask:0xf bank_mask:0xf
    s_nop 1
    v_add_f32_dpp v128, v136, v136 quad_perm:[2,3,0,1] row_mask:0xf bank_mask:0xf
    v_add_f32_dpp v129, v137, v137 quad_perm:[2,3,0,1] row_mask:0xf bank_mask:0xf
    v_add_f32_dpp v130, v138, v138 quad_perm:[2,3,0,1] row_mask:0xf bank_mask:0xf
    v_add_f32_dpp v131, v139, v139 quad_perm:[2,3,0,1] row_mask:0xf bank_mask:0xf
    v_add_f32_dpp v132, v140, v140 quad_perm:[2,3,0,1] row_mask:0xf bank_mask:0xf
    v_add_f32_dpp v133, v141, v141 quad_perm:[2,3,0,1] row_mask:0xf bank_mask:0xf
    s_nop 1
    v_add_f32_dpp v136, v128, v128 row_half_mirror row_mask:0xf bank_mask:0xf
    v_add_f32_dpp v137, v129, v129 row_half_mirror row_mask:0xf bank_mask:0xf
    v_add_f32_dpp v138, v130, v130 row_half_mirror row_mask:0xf bank_mask:0xf
    v_add_f32_dpp v139, v131, v131 row_half_mirror row_mask:0xf bank_mask:0xf
    v_add_f32_dpp v140, v132, v132 row_half_mirror row_mask:0xf bank_mask:0xf
    v_add_f32_dpp v141, v133, v133 row_half_mirror row_mask:0xf bank_mask:0xf
    s_mul_i32 s42, s46, 192
    s_add_u32 s42, s42, 154208
    v_lshlrev_b32 v14, 3, v3
    v_add_u32 v14, s42, v14
    s_lshl_b32 s42, s46, 2
    s_add_u32 s42, s42, 155952
    v_mov_b32 v15, s42
    ds_write_b64 v14, v[136:137] offset:896
    ds_write_b64 v14, v[138:139] offset:960
    ds_write_b64 v14, v[140:141] offset:1024
    v_mov_b32 v19, 1
    ds_write_b32 v15, v19
L_store:
    s_sub_u32 s46, s36, 4
    s_cmp_eq_u32 s46, 7
    s_cbranch_scc0 L_st1
    s_setprio 0
    s_add_u32 s48, s37, 8160
    s_mul_i32 s48, s48, 1152
    s_mov_b32 s60, s16
    s_mov_b32 s61, s17
    s_add_u32 s62, s48, 1152
    s_min_u32 s62, s62, 9437184
    s_mov_b32 s63, 0x00020000
    buffer_load_dwordx4 v[146:149], v1, s[60:63], s48 offen
    buffer_load_dwordx4 v[150:153], v1, s[60:63], s48 offen offset:1024
    v_mov_b32 v155, 155000
    ds_read_b32 v154, v155
    v_mov_b32 v162, 0
    v_mov_b32 v163, 0
    s_waitcnt vmcnt(0) lgkmcnt(0)
    v_lshlrev_b32 v128, 16, v146
    v_and_b32 v129, s66, v146
    v_sub_f32 v128, v128, v154
    v_sub_f32 v129, v129, v154
    v_add_f32 v162, v162, v128
    v_fmac_f32 v163, v128, v128
    v_add_f32 v162, v162, v129
    v_fmac_f32 v163, v129, v129
    v_lshlrev_b32 v128, 16, v147
    v_and_b32 v129, s66, v147
    v_sub_f32 v128, v128, v154
    v_sub_f32 v129, v129, v154
    v_add_f32 v162, v162, v128
    v_fmac_f32 v163, v128, v128
    v_add_f32 v162, v162, v129
    v_fmac_f32 v163, v129, v129
    v_lshlrev_b32 v128, 16, v148
    v_and_b32 v129, s66, v148
    v_sub_f32 v128, v128, v154
    v_sub_f32 v129, v129, v154
    v_add_f32 v162, v162, v128
    v_fmac_f32 v163, v128, v128
    v_add_f32 v162, v162, v129
    v_fmac_f32 v163, v129, v129
    v_lshlrev_b32 v128, 16, v149
    v_and_b32 v129, s66, v149
    v_sub_f32 v128, v128, v154
    v_sub_f32 v129, v129, v154
    v_add_f32 v162, v162, v128
    v_fmac_f32 v163, v128, v128
    v_add_f32 v162, v162, v129
    v_fmac_f32 v163, v129, v129
    s_mov_b64 exec, 0xff
    v_lshlrev_b32 v128, 16, v150
    v_and_b32 v129, s66, v150
    v_sub_f32 v128, v128, v154
    v_sub_f32 v129, v129, v154
    v_add_f32 v162, v162, v128
    v_fmac_f32 v163, v128, v128
    v_add_f32 v162, v162, v129
    v_fmac_f32 v163, v129, v129
    v_lshlrev_b32 v128, 16, v151
    v_and_b32 v129, s66, v151
    v_sub_f32 v128, v128, v154
    v_sub_f32 v129, v129, v154
    v_add_f32 v162, v162, v128
    v_fmac_f32 v163, v128, v128
    v_add_f32 v162, v162, v129
    v_fmac_f32 v163, v129, v129
    v_lshlrev_b32 v128, 16, v152
    v_and_b32 v129, s66, v152
    v_sub_f32 v128, v128, v154
    v_sub_f32 v129, v129, v154
    v_add_f32 v162, v162, v128
    v_fmac_f32 v163, v128, v128
    v_add_f32 v162, v162, v129
    v_fmac_f32 v163, v129, v129
    v_lshlrev_b32 v128, 16, v153
    v_and_b32 v129, s66, v153
    v_sub_f32 v128, v128, v154
    v_sub_f32 v129, v129, v154
    v_add_f32 v162, v162, v128
    v_fmac_f32 v163, v128, v128
    v_add_f32 v162, v162, v129
    v_fmac_f32 v163, v129, v129
    s_mov_b64 exec, -1
    s_nop 1
    v_add_f32_dpp v164, v162, v162 quad_perm:[1,0,3,2] row_mask:0xf bank_mask:0xf
    v_add_f32_dpp v165, v163, v163 quad_perm:[1,0,3,2] row_mask:0xf bank_mask:0xf
    s_nop 1
    v_add_f32_dpp v162, v164, v164 quad_perm:[2,3,0,1] row_mask:0xf bank_mask:0xf
    v_add_f32_dpp v163, v165, v165 quad_perm:[2,3,0,1] row_mask:0xf bank_mask:0xf
    s_nop 1
    v_add_f32_dpp v164, v162, v162 row_half_mirror row_mask:0xf bank_mask:0xf
    v_add_f32_dpp v165, v163, v163 row_half_mirror row_mask:0xf bank_mask:0xf
    s_nop 1
    v_add_f32_dpp v162, v164, v164 row_mirror row_mask:0xf bank_mask:0xf
    v_add_f32_dpp v163, v165, v165 row_mirror row_mask:0xf bank_mask:0xf
    s_nop 1
    v_readlane_b32 s76, v162, 0
    v_readlane_b32 s77, v162, 16
    v_readlane_b32 s78, v162, 32
    v_readlane_b32 s79, v162, 48
    v_readlane_b32 s80, v163, 0
    v_readlane_b32 s81, v163, 16
    v_readlane_b32 s82, v163, 32
    v_readlane_b32 s83, v163, 48
    s_nop 3
    v_mov_b32 v162, s76
    v_add_f32 v162, s77, v162
    v_add_f32 v162, s78, v162
    v_add_f32 v162, s79, v162
    v_mov_b32 v163, s80
    v_add_f32 v163, s81, v163
    v_add_f32 v163, s82, v163
    v_add_f32 v163, s83, v163
    v_mul_f32 v162, 0x3ae38e39, v162
    v_mul_f32 v163, 0x3ae38e39, v163
    v_fma_f32 v163, -v162, v162, v163
    v_max_f32 v163, 0, v163
    v_add_f32 v162, v162, v154
    v_cvt_pk_bf16_f32 v128, v162, v163
    v_lshlrev_b32 v162, 16, v128
    v_sub_f32 v162, v154, v162
    v_and_b32 v163, 0xffff0000, v128
    v_add_f32 v163, 0x3727c5ac, v163
    v_cvt_pk_bf16_f32 v128, v163, v163
    v_lshlrev_b32 v163, 16, v128
    v_sqrt_f32 v163, v163
    s_nop 0
    v_cvt_pk_bf16_f32 v128, v163, v163
    v_lshlrev_b32 v163, 16, v128
    v_rcp_f32 v163, v163
    s_nop 0
    v_mul_f32 v162, v162, v163
    v_mov_b32 v14, 154992
    ds_write_b64 v14, v[162:163]
    v_mov_b32 v19, 1
    v_mov_b32 v14, 156000
    ds_write_b32 v14, v19
    s_branch L_fin
L_st1:
    s_setprio 0
L_park:
    ds_read_b32 v18, v17 offset:32
    s_waitcnt lgkmcnt(0)
    v_cmp_le_u32 vcc, 8, v18
    s_add_u32 s68, s68, 1
    s_bitcmp1_b32 s68, 18
    s_cbranch_scc1 L_parked
    s_cmp_eq_u64 vcc, 0
    s_cbranch_scc1 L_park
L_parked:
    s_add_u32 s47, s46, 1
    s_cmp_eq_u32 s46, 6
    s_cbranch_scc1 L_xrow
    v_mul_u32_u24 v8, 400, v3
    s_mul_i32 s48, s46, 6400
    s_add_u32 s48, s48, 73984
    v_add3_u32 v8, v8, v4, s48
    s_mul_i32 s48, s46, 18432
    s_add_u32 s48, s48, s40
    s_add_u32 s48, s48, s41
    s_add_u32 s49, s48, 9216
SP_5:
    ds_read_b32 v18, v17 offset:80
    s_waitcnt lgkmcnt(0)
    v_cmp_le_u32 vcc, s47, v18
    s_add_u32 s68, s68, 1
    s_bitcmp1_b32 s68, 18
    s_cbranch_scc1 SP_ok5
    s_cmp_eq_u64 vcc, exec
    s_cbranch_scc0 SP_5
SP_ok5:
    ds_read_b128 v[20:23], v8 offset:0
    ds_read_b128 v[24:27], v8 offset:128
    ds_read_b128 v[28:31], v8 offset:256
    ds_read_b128 v[32:35], v8 offset:3200
    ds_read_b128 v[36:39], v8 offset:3328
    ds_read_b128 v[40:43], v8 offset:3456
    s_waitcnt lgkmcnt(5)
    buffer_store_dwordx4 v[20:23], v5, s[32:35], s48 offen offset:0 nt
    s_waitcnt lgkmcnt(4)
    buffer_store_dwordx4 v[24:27], v5, s[32:35], s48 offen offset:128 nt
    s_waitcnt lgkmcnt(3)
    buffer_store_dwordx4 v[28:31], v5, s[32:35], s48 offen offset:256 nt
    s_waitcnt lgkmcnt(2)
    buffer_store_dwordx4 v[32:35], v5, s[32:35], s49 offen offset:0 nt
    s_waitcnt lgkmcnt(1)
    buffer_store_dwordx4 v[36:39], v5, s[32:35], s49 offen offset:128 nt
    s_waitcnt lgkmcnt(0)
    buffer_store_dwordx4 v[40:43], v5, s[32:35], s49 offen offset:256 nt
    s_branch L_fin
L_xrow:
    v_add_u32 v6, 113184, v1
    s_add_u32 s48, s37, 8160
    s_mul_i32 s48, s48, 1152
    s_add_u32 s48, s48, s41
SP_6:
    ds_read_b32 v18, v17 offset:80
    s_waitcnt lgkmcnt(0)
    v_cmp_le_u32 vcc, s47, v18
    s_add_u32 s68, s68, 1
    s_bitcmp1_b32 s68, 18
    s_cbranch_scc1 SP_ok6
    s_cmp_eq_u64 vcc, exec
    s_cbranch_scc0 SP_6
SP_ok6:
    s_mov_b64 exec, 0xffffff
    ds_read_b128 v[44:47], v6
    s_waitcnt lgkmcnt(0)
    buffer_store_dwordx4 v[44:47], v1, s[32:35], s48 offen nt
    s_branch L_fin
L_cons:
    s_mov_b32 s36, s46
    s_setprio 3
    s_mov_b32 s68, 0
    s_mov_b32 s66, 0xffff0000
    s_sub_u32 s43, s27, 3
    s_min_u32 s27, s27, s43
    s_lshl_b32 s27, s27, 7
    s_add_u32 s64, s27, 128
    s_cmp_eq_u32 s64, 384
    s_cselect_b32 s64, 0, s64
    s_add_u32 s65, s64, 128
    s_cmp_eq_u32 s65, 384
    s_cselect_b32 s65, 0, s65
    s_mov_b32 s24, 0
    s_bitcmp1_b32 s39, 0
    s_cselect_b32 s25, 2, 1
    s_mulk_i32 s25, 384
    s_sub_u32 s26, 1152, s25
    s_add_u32 s77, s24, s64
    s_add_u32 s78, s24, s65
    s_add_u32 s79, s25, s27
    s_add_u32 s80, s25, s64
    s_add_u32 s81, s25, s65
    s_add_u32 s82, s26, s27
    s_add_u32 s83, s26, s64
    s_add_u32 s84, s26, s65
    s_mov_b32 s85, 0
    v_and_b32 v6, 3, v0
    v_lshlrev_b32 v6, 2, v6
    v_add_u32 v6, 155904, v6
    s_lshl_b32 s48, s36, 2
    s_add_u32 s48, s48, 155904
    v_mov_b32 v7, s48
    v_and_b32 v1, 15, v0
    v_lshrrev_b32 v2, 4, v0
    v_lshrrev_b32 v4, 2, v1
    v_sub_u32 v4, 0, v4
    v_xor_b32 v4, v4, v2
    v_and_b32 v4, 3, v4
    v_lshlrev_b32 v4, 4, v4
    v_lshl_add_u32 v13, v1, 6, v4
    v_bfe_u32 v4, v0, 2, 2
    v_lshl_add_u32 v5, v2, 3, v4
    v_lshlrev_b32 v5, 7, v5
    v_and_b32 v8, 3, v0
    v_lshl_add_u32 v5, v8, 3, v5
    v_lshrrev_b32 v4, 1, v4
    v_and_b32 v8, 1, v2
    v_lshl_or_b32 v4, v8, 1, v4
    v_xor_b32 v4, s36, v4
    v_lshl_add_u32 v5, v4, 5, v5
    v_add_u32 v14, 24832, v5
    v_min_u32 v4, 2, v1
    v_mul_u32_u24 v4, 2080, v4
    v_lshl_add_u32 v4, v2, 4, v4
    v_add_u32 v12, 147968, v4
    v_add_u32 v15, s54, v12
    v_add_u32 v16, 73984, v13
    v_add_u32 v17, 73984, v14
    v_and_b32 v9, 7, v0
    v_lshlrev_b32 v9, 2, v9
    v_and_b32 v11, 16, v9
    v_mul_u32_u24 v11, 3, v11
    v_add3_u32 v9, v9, v11, 0
    v_add_u32 v9, 155904, v9
    v_mov_b32 v19, 0
    v_mov_b32 v8, 1
    s_mov_b32 s53, 1
    s_mov_b32 s52, 1
    v_lshlrev_b32 v11, 1, v10
    v_add_u32 v11, 156032, v11
    v_add_u32 v10, 152128, v10
    s_waitcnt vmcnt(6)
    s_mov_b32 s43, 0x3e003e00
    v_dot2_f32_bf16 v156, v158, s43, 0
    v_dot2_f32_bf16 v156, v159, s43, v156
    v_dot2_f32_bf16 v156, v160, s43, v156
    v_dot2_f32_bf16 v156, v161, s43, v156
    v_mov_b32 v157, 155000
    v_lshlrev_b32 v150, 16, v146
    v_and_b32 v151, s66, v146
    v_lshlrev_b32 v152, 16, v148
    v_and_b32 v153, s66, v148
    v_sub_f32 v150, v150, v156
    v_sub_f32 v151, v151, v156
    v_mul_f32 v150, v150, v152
    v_mul_f32 v151, v151, v153
    v_cvt_pk_bf16_f32 v146, v150, v151
    v_lshlrev_b32 v150, 16, v147
    v_and_b32 v151, s66, v147
    v_lshlrev_b32 v154, 16, v149
    v_and_b32 v155, s66, v149
    v_sub_f32 v150, v150, v156
    v_sub_f32 v151, v151, v156
    v_mul_f32 v150, v150, v154
    v_mul_f32 v151, v151, v155
    v_cvt_pk_bf16_f32 v147, v150, v151
    s_mov_b32 exec_hi, 0xf
    ds_write_b64 v10, v[146:147]
    ds_write_b128 v11, v[152:155]
    ds_write_b32 v157, v156
    s_mov_b32 exec_hi, -1
    s_waitcnt vmcnt(0)
    ds_write_b32 v7, v8 offset:64
    s_setprio 1
SP_7:
    ds_read_b32 v8, v9 offset:0
    s_waitcnt lgkmcnt(0)
    v_cmp_le_u32 vcc, 1, v8
    s_add_u32 s68, s68, 1
    s_bitcmp1_b32 s68, 18
    s_cbranch_scc1 SP_ok7
    s_cmp_eq_u64 vcc, exec
    s_cbranch_scc0 SP_7
SP_ok7:
    ds_read_b64_tr_b16 v[132:133], v14 offset:0
    ds_read_b64_tr_b16 v[134:135], v14 offset:512
    ds_read_b64_tr_b16 v[136:137], v14 offset:8192
    ds_read_b64_tr_b16 v[138:139], v14 offset:8704
    ds_read_b64_tr_b16 v[140:141], v14 offset:16384
    ds_read_b64_tr_b16 v[142:143], v14 offset:16896
    ds_read_b128 v[104:107], v13 offset:0
    ds_read_b128 v[108:111], v13 offset:1024
    ds_read_b128 v[112:115], v13 offset:2048
    ds_read_b128 v[116:119], v13 offset:3072
    ds_read_b128 v[120:123], v13 offset:4096
    ds_read_b128 v[124:127], v13 offset:5120
    ds_read_b128 v[128:131], v15 offset:0
    s_waitcnt lgkmcnt(5)
    v_mfma_f32_16x16x32_bf16 v[20:23], v[132:135], v[104:107], 0
    v_mfma_f32_16x16x32_bf16 v[24:27], v[136:139], v[104:107], 0
    v_mfma_f32_16x16x32_bf16 v[28:31], v[140:143], v[104:107], 0
    ds_read_b128 v[104:107], v13 offset:6208
    v_mfma_f32_16x16x32_bf16 v[32:35], v[132:135], v[108:111], 0
    ds_read_b64_tr_b16 v[144:145], v14 offset:4096
    v_mfma_f32_16x16x32_bf16 v[36:39], v[136:139], v[108:111], 0
    ds_read_b64_tr_b16 v[146:147], v14 offset:4608
    v_mfma_f32_16x16x32_bf16 v[40:43], v[140:143], v[108:111], 0
    ds_read_b64_tr_b16 v[148:149], v14 offset:12288
    ds_read_b128 v[108:111], v13 offset:7232
    s_waitcnt lgkmcnt(8)
    v_mfma_f32_16x16x32_bf16 v[44:47], v[132:135], v[112:115], 0
    ds_read_b64_tr_b16 v[150:151], v14 offset:12800
    v_mfma_f32_16x16x32_bf16 v[48:51], v[136:139], v[112:115], 0
    ds_read_b64_tr_b16 v[152:153], v14 offset:20480
    v_mfma_f32_16x16x32_bf16 v[52:55], v[140:143], v[112:115], 0
    ds_read_b64_tr_b16 v[154:155], v14 offset:20992
    ds_read_b128 v[112:115], v13 offset:8256
    v_mfma_f32_16x16x32_bf16 v[56:59], v[132:135], v[116:119], 0
    s_mov_b32 m0, s52
    v_mfma_f32_16x16x32_bf16 v[60:63], v[136:139], v[116:119], 0
    s_movrels_b32 s51, s76
    v_mfma_f32_16x16x32_bf16 v[64:67], v[140:143], v[116:119], 0
    ds_read_b128 v[116:119], v13 offset:9280
    s_waitcnt lgkmcnt(11)
    v_mfma_f32_16x16x32_bf16 v[68:71], v[132:135], v[120:123], 0
    v_add_u32 v18, s51, v12
    v_mfma_f32_16x16x32_bf16 v[72:75], v[136:139], v[120:123], 0
    s_add_u32 s52, s52, 1
    v_mfma_f32_16x16x32_bf16 v[76:79], v[140:143], v[120:123], 0
    ds_read_b128 v[120:123], v13 offset:10304
    v_mfma_f32_16x16x32_bf16 v[80:83], v[132:135], v[124:127], 0
    s_min_u32 s59, s53, 4
    v_mfma_f32_16x16x32_bf16 v[84:87], v[136:139], v[124:127], 0
    ds_read_b32 v8, v6 offset:16
    v_mfma_f32_16x16x32_bf16 v[88:91], v[140:143], v[124:127], 0
    ds_read_b128 v[124:127], v13 offset:11328
    s_waitcnt lgkmcnt(13)
    v_mfma_f32_16x16x32_bf16 v[92:95], v[132:135], v[128:131], 0
    v_mfma_f32_16x16x32_bf16 v[96:99], v[136:139], v[128:131], 0
    v_mfma_f32_16x16x32_bf16 v[100:103], v[140:143], v[128:131], 0
    ds_read_b128 v[128:131], v15 offset:64
    s_branch C_mid
C_loop:
    s_waitcnt lgkmcnt(5)
    v_mfma_f32_16x16x32_bf16 v[20:23], v[132:135], v[104:107], v[20:23]
    v_swap_b32 v13, v16
    v_mfma_f32_16x16x32_bf16 v[24:27], v[136:139], v[104:107], v[24:27]
    v_swap_b32 v14, v17
    v_mfma_f32_16x16x32_bf16 v[28:31], v[140:143], v[104:107], v[28:31]
    ds_read_b128 v[104:107], v13 offset:6208
    v_mfma_f32_16x16x32_bf16 v[32:35], v[132:135], v[108:111], v[32:35]
    ds_read_b64_tr_b16 v[144:145], v14 offset:4096
    v_mfma_f32_16x16x32_bf16 v[36:39], v[136:139], v[108:111], v[36:39]
    ds_read_b64_tr_b16 v[146:147], v14 offset:4608
    v_mfma_f32_16x16x32_bf16 v[40:43], v[140:143], v[108:111], v[40:43]
    ds_read_b64_tr_b16 v[148:149], v14 offset:12288
    ds_read_b128 v[108:111], v13 offset:7232
    s_waitcnt lgkmcnt(8)
    v_mfma_f32_16x16x32_bf16 v[44:47], v[132:135], v[112:115], v[44:47]
    ds_read_b64_tr_b16 v[150:151], v14 offset:12800
    v_mfma_f32_16x16x32_bf16 v[48:51], v[136:139], v[112:115], v[48:51]
    ds_read_b64_tr_b16 v[152:153], v14 offset:20480
    v_mfma_f32_16x16x32_bf16 v[52:55], v[140:143], v[112:115], v[52:55]
    ds_read_b64_tr_b16 v[154:155], v14 offset:20992
    ds_read_b128 v[112:115], v13 offset:8256
    v_mfma_f32_16x16x32_bf16 v[56:59], v[132:135], v[116:119], v[56:59]
    s_mov_b32 m0, s52
    v_mfma_f32_16x16x32_bf16 v[60:63], v[136:139], v[116:119], v[60:63]
    s_movrels_b32 s51, s76
    v_mfma_f32_16x16x32_bf16 v[64:67], v[140:143], v[116:119], v[64:67]
    ds_read_b128 v[116:119], v13 offset:9280
    s_waitcnt lgkmcnt(11)
    v_mfma_f32_16x16x32_bf16 v[68:71], v[132:135], v[120:123], v[68:71]
    v_add_u32 v18, s51, v12
    v_mfma_f32_16x16x32_bf16 v[72:75], v[136:139], v[120:123], v[72:75]
    s_add_u32 s52, s52, 1
    v_mfma_f32_16x16x32_bf16 v[76:79], v[140:143], v[120:123], v[76:79]
    ds_read_b128 v[120:123], v13 offset:10304
    v_mfma_f32_16x16x32_bf16 v[80:83], v[132:135], v[124:127], v[80:83]
    s_min_u32 s59, s53, 4
    v_mfma_f32_16x16x32_bf16 v[84:87], v[136:139], v[124:127], v[84:87]
    ds_read_b32 v8, v6 offset:16
    v_mfma_f32_16x16x32_bf16 v[88:91], v[140:143], v[124:127], v[88:91]
    ds_read_b128 v[124:127], v13 offset:11328
    s_waitcnt lgkmcnt(13)
    v_mfma_f32_16x16x32_bf16 v[92:95], v[132:135], v[128:131], v[92:95]
    v_mfma_f32_16x16x32_bf16 v[96:99], v[136:139], v[128:131], v[96:99]
    v_mfma_f32_16x16x32_bf16 v[100:103], v[140:143], v[128:131], v[100:103]
    ds_read_b128 v[128:131], v15 offset:64
C_mid:
    s_waitcnt lgkmcnt(6)
    v_mfma_f32_16x16x32_bf16 v[20:23], v[144:147], v[104:107], v[20:23]
    v_mfma_f32_16x16x32_bf16 v[24:27], v[148:151], v[104:107], v[24:27]
    s_waitcnt lgkmcnt(2)
    v_cmp_le_u32 vcc, s59, v8
    v_mfma_f32_16x16x32_bf16 v[28:31], v[152:155], v[104:107], v[28:31]
    s_cmp_eq_u64 vcc, exec
    s_cbranch_scc0 SP_8
SP_ok8:
    v_mfma_f32_16x16x32_bf16 v[32:35], v[144:147], v[108:111], v[32:35]
    ds_read_b64_tr_b16 v[132:133], v14 offset:24576
    v_mfma_f32_16x16x32_bf16 v[36:39], v[148:151], v[108:111], v[36:39]
    ds_read_b64_tr_b16 v[134:135], v14 offset:25088
    v_mfma_f32_16x16x32_bf16 v[40:43], v[152:155], v[108:111], v[40:43]
    ds_read_b64_tr_b16 v[136:137], v14 offset:32768
    v_mfma_f32_16x16x32_bf16 v[44:47], v[144:147], v[112:115], v[44:47]
    ds_read_b64_tr_b16 v[138:139], v14 offset:33280
    v_mfma_f32_16x16x32_bf16 v[48:51], v[148:151], v[112:115], v[48:51]
    v_add_u32 v19, 1, v19
    ds_read_b64_tr_b16 v[140:141], v14 offset:40960
    v_mfma_f32_16x16x32_bf16 v[52:55], v[152:155], v[112:115], v[52:55]
    ds_read_b64_tr_b16 v[142:143], v14 offset:41472
    s_waitcnt lgkmcnt(6)
    ds_write_b32 v7, v19 offset:32
    v_mfma_f32_16x16x32_bf16 v[56:59], v[144:147], v[116:119], v[56:59]
    ds_read_b128 v[104:107], v13 offset:12416
    v_mfma_f32_16x16x32_bf16 v[60:63], v[148:151], v[116:119], v[60:63]
    ds_read_b128 v[108:111], v13 offset:13440
    v_mfma_f32_16x16x32_bf16 v[64:67], v[152:155], v[116:119], v[64:67]
    ds_read_b128 v[112:115], v13 offset:14464
    ds_read_b128 v[116:119], v13 offset:15488
    v_mfma_f32_16x16x32_bf16 v[68:71], v[144:147], v[120:123], v[68:71]
    v_mfma_f32_16x16x32_bf16 v[72:75], v[148:151], v[120:123], v[72:75]
    v_mfma_f32_16x16x32_bf16 v[76:79], v[152:155], v[120:123], v[76:79]
    ds_read_b128 v[120:123], v13 offset:16512
    v_mfma_f32_16x16x32_bf16 v[80:83], v[144:147], v[124:127], v[80:83]
    v_mfma_f32_16x16x32_bf16 v[84:87], v[148:151], v[124:127], v[84:87]
    v_mfma_f32_16x16x32_bf16 v[88:91], v[152:155], v[124:127], v[88:91]
    ds_read_b128 v[124:127], v13 offset:17536
    v_mfma_f32_16x16x32_bf16 v[92:95], v[144:147], v[128:131], v[92:95]
    v_mfma_f32_16x16x32_bf16 v[96:99], v[148:151], v[128:131], v[96:99]
    v_mfma_f32_16x16x32_bf16 v[100:103], v[152:155], v[128:131], v[100:103]
    ds_read_b128 v[128:131], v18 offset:0
    s_waitcnt lgkmcnt(5)
    v_mfma_f32_16x16x32_bf16 v[20:23], v[132:135], v[104:107], v[20:23]
    v_mfma_f32_16x16x32_bf16 v[24:27], v[136:139], v[104:107], v[24:27]
    v_mfma_f32_16x16x32_bf16 v[28:31], v[140:143], v[104:107], v[28:31]
    ds_read_b128 v[104:107], v13 offset:18624
    v_mfma_f32_16x16x32_bf16 v[32:35], v[132:135], v[108:111], v[32:35]
    ds_read_b64_tr_b16 v[144:145], v14 offset:28672
    v_mfma_f32_16x16x32_bf16 v[36:39], v[136:139], v[108:111], v[36:39]
    ds_read_b64_tr_b16 v[146:147], v14 offset:29184
    v_mfma_f32_16x16x32_bf16 v[40:43], v[140:143], v[108:111], v[40:43]
    ds_read_b64_tr_b16 v[148:149], v14 offset:36864
    ds_read_b128 v[108:111], v13 offset:19648
    s_waitcnt lgkmcnt(8)
    v_mfma_f32_16x16x32_bf16 v[44:47], v[132:135], v[112:115], v[44:47]
    ds_read_b64_tr_b16 v[150:151], v14 offset:37376
    v_mfma_f32_16x16x32_bf16 v[48:51], v[136:139], v[112:115], v[48:51]
    ds_read_b64_tr_b16 v[152:153], v14 offset:45056
    v_mfma_f32_16x16x32_bf16 v[52:55], v[140:143], v[112:115], v[52:55]
    ds_read_b64_tr_b16 v[154:155], v14 offset:45568
    ds_read_b128 v[112:115], v13 offset:20672
    v_mfma_f32_16x16x32_bf16 v[56:59], v[132:135], v[116:119], v[56:59]
    s_mov_b32 m0, s52
    v_mfma_f32_16x16x32_bf16 v[60:63], v[136:139], v[116:119], v[60:63]
    s_movrels_b32 s51, s76
    v_mfma_f32_16x16x32_bf16 v[64:67], v[140:143], v[116:119], v[64:67]
    ds_read_b128 v[116:119], v13 offset:21696
    s_waitcnt lgkmcnt(11)
    v_mfma_f32_16x16x32_bf16 v[68:71], v[132:135], v[120:123], v[68:71]
    v_add_u32 v15, s51, v12
    v_mfma_f32_16x16x32_bf16 v[72:75], v[136:139], v[120:123], v[72:75]
    s_add_u32 s52, s52, 1
    v_mfma_f32_16x16x32_bf16 v[76:79], v[140:143], v[120:123], v[76:79]
    ds_read_b128 v[120:123], v13 offset:22720
    v_mfma_f32_16x16x32_bf16 v[80:83], v[132:135], v[124:127], v[80:83]
    s_add_u32 s53, s53, 1
    v_mfma_f32_16x16x32_bf16 v[84:87], v[136:139], v[124:127], v[84:87]
    s_mov_b32 s59, s53
    ds_read_b32 v8, v6 offset:0
    v_mfma_f32_16x16x32_bf16 v[88:91], v[140:143], v[124:127], v[88:91]
    ds_read_b128 v[124:127], v13 offset:23744
    s_waitcnt lgkmcnt(13)
    v_mfma_f32_16x16x32_bf16 v[92:95], v[132:135], v[128:131], v[92:95]
    v_mfma_f32_16x16x32_bf16 v[96:99], v[136:139], v[128:131], v[96:99]
    v_mfma_f32_16x16x32_bf16 v[100:103], v[140:143], v[128:131], v[100:103]
    ds_read_b128 v[128:131], v18 offset:64
    s_waitcnt lgkmcnt(6)
    v_mfma_f32_16x16x32_bf16 v[20:23], v[144:147], v[104:107], v[20:23]
    v_mfma_f32_16x16x32_bf16 v[24:27], v[148:151], v[104:107], v[24:27]
    s_waitcnt lgkmcnt(2)
    v_cmp_le_u32 vcc, s59, v8
    v_mfma_f32_16x16x32_bf16 v[28:31], v[152:155], v[104:107], v[28:31]
    s_cmp_eq_u64 vcc, exec
    s_cbranch_scc0 SP_9
SP_ok9:
    v_mfma_f32_16x16x32_bf16 v[32:35], v[144:147], v[108:111], v[32:35]
    ds_read_b64_tr_b16 v[132:133], v17 offset:0
    v_mfma_f32_16x16x32_bf16 v[36:39], v[148:151], v[108:111], v[36:39]
    ds_read_b64_tr_b16 v[134:135], v17 offset:512
    v_mfma_f32_16x16x32_bf16 v[40:43], v[152:155], v[108:111], v[40:43]
    ds_read_b64_tr_b16 v[136:137], v17 offset:8192
    v_mfma_f32_16x16x32_bf16 v[44:47], v[144:147], v[112:115], v[44:47]
    ds_read_b64_tr_b16 v[138:139], v17 offset:8704
    v_mfma_f32_16x16x32_bf16 v[48:51], v[148:151], v[112:115], v[48:51]
    v_add_u32 v19, 1, v19
    ds_read_b64_tr_b16 v[140:141], v17 offset:16384
    v_mfma_f32_16x16x32_bf16 v[52:55], v[152:155], v[112:115], v[52:55]
    ds_read_b64_tr_b16 v[142:143], v17 offset:16896
    s_waitcnt lgkmcnt(6)
    ds_write_b32 v7, v19 offset:32
    v_mfma_f32_16x16x32_bf16 v[56:59], v[144:147], v[116:119], v[56:59]
    ds_read_b128 v[104:107], v16 offset:0
    v_mfma_f32_16x16x32_bf16 v[60:63], v[148:151], v[116:119], v[60:63]
    ds_read_b128 v[108:111], v16 offset:1024
    v_mfma_f32_16x16x32_bf16 v[64:67], v[152:155], v[116:119], v[64:67]
    ds_read_b128 v[112:115], v16 offset:2048
    ds_read_b128 v[116:119], v16 offset:3072
    v_mfma_f32_16x16x32_bf16 v[68:71], v[144:147], v[120:123], v[68:71]
    v_mfma_f32_16x16x32_bf16 v[72:75], v[148:151], v[120:123], v[72:75]
    v_mfma_f32_16x16x32_bf16 v[76:79], v[152:155], v[120:123], v[76:79]
    ds_read_b128 v[120:123], v16 offset:4096
    v_mfma_f32_16x16x32_bf16 v[80:83], v[144:147], v[124:127], v[80:83]
    v_mfma_f32_16x16x32_bf16 v[84:87], v[148:151], v[124:127], v[84:87]
    v_mfma_f32_16x16x32_bf16 v[88:91], v[152:155], v[124:127], v[88:91]
    ds_read_b128 v[124:127], v16 offset:5120
    v_mfma_f32_16x16x32_bf16 v[92:95], v[144:147], v[128:131], v[92:95]
    v_mfma_f32_16x16x32_bf16 v[96:99], v[148:151], v[128:131], v[96:99]
    v_mfma_f32_16x16x32_bf16 v[100:103], v[152:155], v[128:131], v[100:103]
    ds_read_b128 v[128:131], v15 offset:0
    s_cmp_eq_u32 s53, 5
    s_cbranch_scc0 C_loop
    s_waitcnt lgkmcnt(6)
    v_mfma_f32_16x16x32_bf16 v[20:23], v[132:135], v[104:107], v[20:23]
    ds_read_b64_tr_b16 v[144:145], v17 offset:4096
    v_mfma_f32_16x16x32_bf16 v[24:27], v[136:139], v[104:107], v[24:27]
    ds_read_b64_tr_b16 v[146:147], v17 offset:4608
    v_mfma_f32_16x16x32_bf16 v[28:31], v[140:143], v[104:107], v[28:31]
    ds_read_b64_tr_b16 v[148:149], v17 offset:12288
    ds_read_b128 v[104:107], v16 offset:6208
    s_waitcnt lgkmcnt(9)
    v_mfma_f32_16x16x32_bf16 v[32:35], v[132:135], v[108:111], v[32:35]
    ds_read_b64_tr_b16 v[150:151], v17 offset:12800
    v_mfma_f32_16x16x32_bf16 v[36:39], v[136:139], v[108:111], v[36:39]
    ds_read_b64_tr_b16 v[152:153], v17 offset:20480
    v_mfma_f32_16x16x32_bf16 v[40:43], v[140:143], v[108:111], v[40:43]
    ds_read_b64_tr_b16 v[154:155], v17 offset:20992
    ds_read_b128 v[108:111], v16 offset:7232
    s_waitcnt lgkmcnt(8)
    v_mfma_f32_16x16x32_bf16 v[92:95], v[132:135], v[128:131], v[92:95]
    v_and_b32 v4, 7, v0
    v_cmp_gt_u32 vcc, 4, v4
    v_mfma_f32_16x16x32_bf16 v[96:99], v[136:139], v[128:131], v[96:99]
    v_lshlrev_b32 v4, 2, v4
    v_add_u32 v4, 155920, v4
    v_mfma_f32_16x16x32_bf16 v[100:103], v[140:143], v[128:131], v[100:103]
    ds_read_b128 v[128:131], v15 offset:64
    v_mfma_f32_16x16x32_bf16 v[44:47], v[132:135], v[112:115], v[44:47]
    v_cndmask_b32 v14, 8, 5, vcc
    ds_read_b32 v18, v4
    v_mfma_f32_16x16x32_bf16 v[48:51], v[136:139], v[112:115], v[48:51]
    v_lshlrev_b32 v3, 3, v1
    v_add_u32 v3, 154208, v3
    v_mfma_f32_16x16x32_bf16 v[52:55], v[140:143], v[112:115], v[52:55]
    ds_read_b128 v[112:115], v16 offset:8256
    s_waitcnt lgkmcnt(4)
    v_mfma_f32_16x16x32_bf16 v[20:23], v[144:147], v[104:107], v[20:23]
    v_mul_u32_u24 v5, 400, v1
    v_lshl_add_u32 v5, v2, 3, v5
    v_mfma_f32_16x16x32_bf16 v[24:27], v[148:151], v[104:107], v[24:27]
    s_lshl_b32 s48, s36, 5
    s_add_u32 s48, s48, 73984
    v_mfma_f32_16x16x32_bf16 v[28:31], v[152:155], v[104:107], v[28:31]
    v_add_u32 v5, s48, v5
    s_waitcnt lgkmcnt(2)
    v_mfma_f32_16x16x32_bf16 v[92:95], v[144:147], v[128:131], v[92:95]
    v_mfma_f32_16x16x32_bf16 v[96:99], v[148:151], v[128:131], v[96:99]
    s_waitcnt lgkmcnt(1)
    v_cmp_le_u32 vcc, v14, v18
    v_mfma_f32_16x16x32_bf16 v[100:103], v[152:155], v[128:131], v[100:103]
    s_cmp_eq_u64 vcc, exec
    s_cbranch_scc0 SP_L
SP_Lok:
    ds_read_b64 v[10:11], v3 offset:0
    ds_read_b64 v[12:13], v3 offset:128
    v_mfma_f32_16x16x32_bf16 v[32:35], v[144:147], v[108:111], v[32:35]
    v_mfma_f32_16x16x32_bf16 v[36:39], v[148:151], v[108:111], v[36:39]
    v_mov_b32_dpp v156, v92 row_newbcast:0 row_mask:0xf bank_mask:0xf
    v_mov_b32_dpp v158, v92 row_newbcast:1 row_mask:0xf bank_mask:0xf
    v_mov_b32_dpp v157, v93 row_newbcast:0 row_mask:0xf bank_mask:0xf
    v_mov_b32_dpp v159, v93 row_newbcast:1 row_mask:0xf bank_mask:0xf
    v_mov_b32_dpp v160, v94 row_newbcast:0 row_mask:0xf bank_mask:0xf
    v_mfma_f32_16x16x32_bf16 v[40:43], v[152:155], v[108:111], v[40:43]
    v_mov_b32_dpp v162, v94 row_newbcast:1 row_mask:0xf bank_mask:0xf
    v_mov_b32_dpp v161, v95 row_newbcast:0 row_mask:0xf bank_mask:0xf
    v_mov_b32_dpp v163, v95 row_newbcast:1 row_mask:0xf bank_mask:0xf
    v_mov_b32_dpp v164, v96 row_newbcast:0 row_mask:0xf bank_mask:0xf
    v_mov_b32_dpp v8, v96 row_newbcast:1 row_mask:0xf bank_mask:0xf
    v_mfma_f32_16x16x32_bf16 v[56:59], v[132:135], v[116:119], v[56:59]
    v_mov_b32_dpp v165, v97 row_newbcast:0 row_mask:0xf bank_mask:0xf
    v_mov_b32_dpp v9, v97 row_newbcast:1 row_mask:0xf bank_mask:0xf
    v_mov_b32_dpp v104, v98 row_newbcast:0 row_mask:0xf bank_mask:0xf
    v_mov_b32_dpp v106, v98 row_newbcast:1 row_mask:0xf bank_mask:0xf
    v_mov_b32_dpp v105, v99 row_newbcast:0 row_mask:0xf bank_mask:0xf
    v_mfma_f32_16x16x32_bf16 v[60:63], v[136:139], v[116:119], v[60:63]
    v_mov_b32_dpp v107, v99 row_newbcast:1 row_mask:0xf bank_mask:0xf
    v_mov_b32_dpp v128, v100 row_newbcast:0 row_mask:0xf bank_mask:0xf
    v_mov_b32_dpp v130, v100 row_newbcast:1 row_mask:0xf bank_mask:0xf
    v_mov_b32_dpp v129, v101 row_newbcast:0 row_mask:0xf bank_mask:0xf
    v_mov_b32_dpp v131, v101 row_newbcast:1 row_mask:0xf bank_mask:0xf
    v_mfma_f32_16x16x32_bf16 v[64:67], v[140:143], v[116:119], v[64:67]
    ds_read_b128 v[116:119], v16 offset:9280
    v_mov_b32_dpp v108, v102 row_newbcast:0 row_mask:0xf bank_mask:0xf
    v_mov_b32_dpp v110, v102 row_newbcast:1 row_mask:0xf bank_mask:0xf
    v_mov_b32_dpp v109, v103 row_newbcast:0 row_mask:0xf bank_mask:0xf
    v_mov_b32_dpp v111, v103 row_newbcast:1 row_mask:0xf bank_mask:0xf
    s_waitcnt lgkmcnt(3)
    v_mfma_f32_16x16x32_bf16 v[44:47], v[144:147], v[112:115], v[44:47]
    s_waitcnt lgkmcnt(2)
    v_fma_f32 v20, v20, v11, v158
    v_fma_f32 v21, v21, v11, v159
    v_fma_f32 v22, v22, v11, v162
    v_fma_f32 v23, v23, v11, v163
    v_fma_f32 v24, v24, v11, v8
    v_fma_f32 v25, v25, v11, v9
    v_mfma_f32_16x16x32_bf16 v[48:51], v[148:151], v[112:115], v[48:51]
    v_fma_f32 v26, v26, v11, v106
    v_fma_f32 v27, v27, v11, v107
    v_fma_f32 v28, v28, v11, v130
    v_fma_f32 v29, v29, v11, v131
    v_fma_f32 v30, v30, v11, v110
    v_fma_f32 v31, v31, v11, v111
    v_mfma_f32_16x16x32_bf16 v[52:55], v[152:155], v[112:115], v[52:55]
    v_fmac_f32 v20, v156, v10
    v_fmac_f32 v21, v157, v10
    v_fmac_f32 v22, v160, v10
    v_fmac_f32 v23, v161, v10
    v_fmac_f32 v24, v164, v10
    v_fmac_f32 v25, v165, v10
    v_mfma_f32_16x16x32_bf16 v[68:71], v[132:135], v[120:123], v[68:71]
    v_fmac_f32 v26, v104, v10
    v_fmac_f32 v27, v105, v10
    v_fmac_f32 v28, v128, v10
    v_fmac_f32 v29, v129, v10
    v_fmac_f32 v30, v108, v10
    v_fmac_f32 v31, v109, v10
    v_mfma_f32_16x16x32_bf16 v[72:75], v[136:139], v[120:123], v[72:75]
    ds_read_b64 v[10:11], v3 offset:256
    v_cvt_pk_bf16_f32 v20, v20, v21
    v_cvt_pk_bf16_f32 v21, v22, v23
    v_cvt_pk_bf16_f32 v24, v24, v25
    v_cvt_pk_bf16_f32 v25, v26, v27
    v_cvt_pk_bf16_f32 v28, v28, v29
    v_mfma_f32_16x16x32_bf16 v[76:79], v[140:143], v[120:123], v[76:79]
    ds_read_b128 v[120:123], v16 offset:10304
    v_cvt_pk_bf16_f32 v29, v30, v31
    v_mov_b32 v19, 1
    ds_write_b64 v5, v[20:21] offset:0
    ds_write_b64 v5, v[24:25] offset:128
    ds_write_b64 v5, v[28:29] offset:256
    ds_write_b32 v7, v19 offset:80
    s_waitcnt lgkmcnt(6)
    v_mfma_f32_16x16x32_bf16 v[56:59], v[144:147], v[116:119], v[56:59]
    v_fma_f32 v32, v32, v13, v158
    v_fma_f32 v33, v33, v13, v159
    v_fma_f32 v34, v34, v13, v162
    v_fma_f32 v35, v35, v13, v163
    v_fma_f32 v36, v36, v13, v8
    v_fma_f32 v37, v37, v13, v9
    v_mfma_f32_16x16x32_bf16 v[60:63], v[148:151], v[116:119], v[60:63]
    v_fma_f32 v38, v38, v13, v106
    v_fma_f32 v39, v39, v13, v107
    v_fma_f32 v40, v40, v13, v130
    v_fma_f32 v41, v41, v13, v131
    v_fma_f32 v42, v42, v13, v110
    v_fma_f32 v43, v43, v13, v111
    v_mfma_f32_16x16x32_bf16 v[64:67], v[152:155], v[116:119], v[64:67]
    v_fmac_f32 v32, v156, v12
    v_fmac_f32 v33, v157, v12
    v_fmac_f32 v34, v160, v12
    v_fmac_f32 v35, v161, v12
    v_fmac_f32 v36, v164, v12
    v_fmac_f32 v37, v165, v12
    v_mfma_f32_16x16x32_bf16 v[80:83], v[132:135], v[124:127], v[80:83]
    v_fmac_f32 v38, v104, v12
    v_fmac_f32 v39, v105, v12
    v_fmac_f32 v40, v128, v12
    v_fmac_f32 v41, v129, v12
    v_fmac_f32 v42, v108, v12
    v_fmac_f32 v43, v109, v12
    v_mfma_f32_16x16x32_bf16 v[84:87], v[136:139], v[124:127], v[84:87]
    ds_read_b64 v[12:13], v3 offset:384
    v_cvt_pk_bf16_f32 v32, v32, v33
    v_cvt_pk_bf16_f32 v33, v34, v35
    v_cvt_pk_bf16_f32 v36, v36, v37
    v_cvt_pk_bf16_f32 v37, v38, v39
    v_cvt_pk_bf16_f32 v40, v40, v41
    v_mfma_f32_16x16x32_bf16 v[88:91], v[140:143], v[124:127], v[88:91]
    ds_read_b128 v[124:127], v16 offset:11328
    v_cvt_pk_bf16_f32 v41, v42, v43
    v_mov_b32 v19, 2
    ds_write_b64 v5, v[32:33] offset:6400
    ds_write_b64 v5, v[36:37] offset:6528
    ds_write_b64 v5, v[40:41] offset:6656
    ds_write_b32 v7, v19 offset:80
    s_waitcnt lgkmcnt(10)
    v_mfma_f32_16x16x32_bf16 v[68:71], v[144:147], v[120:123], v[68:71]
    v_fma_f32 v44, v44, v11, v158
    v_fma_f32 v45, v45, v11, v159
    v_fma_f32 v46, v46, v11, v162
    v_fma_f32 v47, v47, v11, v163
    v_fma_f32 v48, v48, v11, v8
    v_fma_f32 v49, v49, v11, v9
    v_mfma_f32_16x16x32_bf16 v[72:75], v[148:151], v[120:123], v[72:75]
    v_fma_f32 v50, v50, v11, v106
    v_fma_f32 v51, v51, v11, v107
    v_fma_f32 v52, v52, v11, v130
    v_fma_f32 v53, v53, v11, v131
    v_fma_f32 v54, v54, v11, v110
    v_fma_f32 v55, v55, v11, v111
    v_mfma_f32_16x16x32_bf16 v[76:79], v[152:155], v[120:123], v[76:79]
    v_fmac_f32 v44, v156, v10
    v_fmac_f32 v45, v157, v10
    v_fmac_f32 v46, v160, v10
    v_fmac_f32 v47, v161, v10
    v_fmac_f32 v48, v164, v10
    v_fmac_f32 v49, v165, v10
    s_waitcnt lgkmcnt(4)
    v_mfma_f32_16x16x32_bf16 v[80:83], v[144:147], v[124:127], v[80:83]
    v_fmac_f32 v50, v104, v10
    v_fmac_f32 v51, v105, v10
    v_fmac_f32 v52, v128, v10
    v_fmac_f32 v53, v129, v10
    v_fmac_f32 v54, v108, v10
    v_fmac_f32 v55, v109, v10
    v_mfma_f32_16x16x32_bf16 v[84:87], v[148:151], v[124:127], v[84:87]
    ds_read_b64 v[10:11], v3 offset:512
    v_cvt_pk_bf16_f32 v44, v44, v45
    v_cvt_pk_bf16_f32 v45, v46, v47
    v_cvt_pk_bf16_f32 v48, v48, v49
    v_cvt_pk_bf16_f32 v49, v50, v51
    v_cvt_pk_bf16_f32 v52, v52, v53
    v_mfma_f32_16x16x32_bf16 v[88:91], v[152:155], v[124:127], v[88:91]
    v_cvt_pk_bf16_f32 v53, v54, v55
    v_mov_b32 v19, 3
    ds_write_b64 v5, v[44:45] offset:12800
    ds_write_b64 v5, v[48:49] offset:12928
    ds_write_b64 v5, v[52:53] offset:13056
    ds_write_b32 v7, v19 offset:80
    v_mov_b32 v4, 156000
    v_pk_fma_f32 v[56:57], v[56:57], v[12:13], v[158:159] op_sel:[0,1,0] op_sel_hi:[1,1,1]
    v_pk_fma_f32 v[58:59], v[58:59], v[12:13], v[162:163] op_sel:[0,1,0] op_sel_hi:[1,1,1]
    v_pk_fma_f32 v[60:61], v[60:61], v[12:13], v[8:9] op_sel:[0,1,0] op_sel_hi:[1,1,1]
    v_pk_fma_f32 v[62:63], v[62:63], v[12:13], v[106:107] op_sel:[0,1,0] op_sel_hi:[1,1,1]
    v_pk_fma_f32 v[64:65], v[64:65], v[12:13], v[130:131] op_sel:[0,1,0] op_sel_hi:[1,1,1]
    v_pk_fma_f32 v[66:67], v[66:67], v[12:13], v[110:111] op_sel:[0,1,0] op_sel_hi:[1,1,1]
    v_pk_fma_f32 v[56:57], v[156:157], v[12:13], v[56:57] op_sel:[0,0,0] op_sel_hi:[1,0,1]
    v_pk_fma_f32 v[58:59], v[160:161], v[12:13], v[58:59] op_sel:[0,0,0] op_sel_hi:[1,0,1]
    v_pk_fma_f32 v[60:61], v[164:165], v[12:13], v[60:61] op_sel:[0,0,0] op_sel_hi:[1,0,1]
    v_pk_fma_f32 v[62:63], v[104:105], v[12:13], v[62:63] op_sel:[0,0,0] op_sel_hi:[1,0,1]
    v_pk_fma_f32 v[64:65], v[128:129], v[12:13], v[64:65] op_sel:[0,0,0] op_sel_hi:[1,0,1]
    v_pk_fma_f32 v[66:67], v[108:109], v[12:13], v[66:67] op_sel:[0,0,0] op_sel_hi:[1,0,1]
    ds_read_b64 v[12:13], v3 offset:640
    v_cvt_pk_bf16_f32 v56, v56, v57
    v_cvt_pk_bf16_f32 v57, v58, v59
    v_cvt_pk_bf16_f32 v60, v60, v61
    v_cvt_pk_bf16_f32 v61, v62, v63
    v_cvt_pk_bf16_f32 v64, v64, v65
    v_cvt_pk_bf16_f32 v65, v66, v67
    v_mov_b32 v19, 4
    ds_write_b64 v5, v[56:57] offset:19200
    ds_write_b64 v5, v[60:61] offset:19328
    ds_write_b64 v5, v[64:65] offset:19456
    ds_write_b32 v7, v19 offset:80
    s_waitcnt lgkmcnt(9)
    v_pk_fma_f32 v[68:69], v[68:69], v[10:11], v[158:159] op_sel:[0,1,0] op_sel_hi:[1,1,1]
    v_pk_fma_f32 v[70:71], v[70:71], v[10:11], v[162:163] op_sel:[0,1,0] op_sel_hi:[1,1,1]
    v_pk_fma_f32 v[72:73], v[72:73], v[10:11], v[8:9] op_sel:[0,1,0] op_sel_hi:[1,1,1]
    v_pk_fma_f32 v[74:75], v[74:75], v[10:11], v[106:107] op_sel:[0,1,0] op_sel_hi:[1,1,1]
    v_pk_fma_f32 v[76:77], v[76:77], v[10:11], v[130:131] op_sel:[0,1,0] op_sel_hi:[1,1,1]
    v_pk_fma_f32 v[78:79], v[78:79], v[10:11], v[110:111] op_sel:[0,1,0] op_sel_hi:[1,1,1]
    v_pk_fma_f32 v[68:69], v[156:157], v[10:11], v[68:69] op_sel:[0,0,0] op_sel_hi:[1,0,1]
    v_pk_fma_f32 v[70:71], v[160:161], v[10:11], v[70:71] op_sel:[0,0,0] op_sel_hi:[1,0,1]
    v_pk_fma_f32 v[72:73], v[164:165], v[10:11], v[72:73] op_sel:[0,0,0] op_sel_hi:[1,0,1]
    v_pk_fma_f32 v[74:75], v[104:105], v[10:11], v[74:75] op_sel:[0,0,0] op_sel_hi:[1,0,1]
    v_pk_fma_f32 v[76:77], v[128:129], v[10:11], v[76:77] op_sel:[0,0,0] op_sel_hi:[1,0,1]
    v_pk_fma_f32 v[78:79], v[108:109], v[10:11], v[78:79] op_sel:[0,0,0] op_sel_hi:[1,0,1]
    v_cvt_pk_bf16_f32 v68, v68, v69
    v_cvt_pk_bf16_f32 v69, v70, v71
    v_cvt_pk_bf16_f32 v72, v72, v73
    v_cvt_pk_bf16_f32 v73, v74, v75
    v_cvt_pk_bf16_f32 v76, v76, v77
    v_cvt_pk_bf16_f32 v77, v78, v79
    v_mov_b32 v19, 5
    ds_write_b64 v5, v[68:69] offset:25600
    ds_write_b64 v5, v[72:73] offset:25728
    ds_write_b64 v5, v[76:77] offset:25856
    ds_write_b32 v7, v19 offset:80
    s_waitcnt lgkmcnt(8)
    v_pk_fma_f32 v[80:81], v[80:81], v[12:13], v[158:159] op_sel:[0,1,0] op_sel_hi:[1,1,1]
    v_pk_fma_f32 v[82:83], v[82:83], v[12:13], v[162:163] op_sel:[0,1,0] op_sel_hi:[1,1,1]
    v_pk_fma_f32 v[84:85], v[84:85], v[12:13], v[8:9] op_sel:[0,1,0] op_sel_hi:[1,1,1]
    v_pk_fma_f32 v[86:87], v[86:87], v[12:13], v[106:107] op_sel:[0,1,0] op_sel_hi:[1,1,1]
    v_pk_fma_f32 v[88:89], v[88:89], v[12:13], v[130:131] op_sel:[0,1,0] op_sel_hi:[1,1,1]
    v_pk_fma_f32 v[90:91], v[90:91], v[12:13], v[110:111] op_sel:[0,1,0] op_sel_hi:[1,1,1]
    v_pk_fma_f32 v[80:81], v[156:157], v[12:13], v[80:81] op_sel:[0,0,0] op_sel_hi:[1,0,1]
    v_pk_fma_f32 v[82:83], v[160:161], v[12:13], v[82:83] op_sel:[0,0,0] op_sel_hi:[1,0,1]
    v_pk_fma_f32 v[84:85], v[164:165], v[12:13], v[84:85] op_sel:[0,0,0] op_sel_hi:[1,0,1]
    v_pk_fma_f32 v[86:87], v[104:105], v[12:13], v[86:87] op_sel:[0,0,0] op_sel_hi:[1,0,1]
    v_pk_fma_f32 v[88:89], v[128:129], v[12:13], v[88:89] op_sel:[0,0,0] op_sel_hi:[1,0,1]
    v_pk_fma_f32 v[90:91], v[108:109], v[12:13], v[90:91] op_sel:[0,0,0] op_sel_hi:[1,0,1]
    v_cvt_pk_bf16_f32 v80, v80, v81
    v_cvt_pk_bf16_f32 v81, v82, v83
    v_cvt_pk_bf16_f32 v84, v84, v85
    v_cvt_pk_bf16_f32 v85, v86, v87
    v_cvt_pk_bf16_f32 v88, v88, v89
    v_cvt_pk_bf16_f32 v89, v90, v91
    v_mov_b32 v19, 6
    ds_write_b64 v5, v[80:81] offset:32000
    ds_write_b64 v5, v[84:85] offset:32128
    ds_write_b64 v5, v[88:89] offset:32256
    ds_write_b32 v7, v19 offset:80
SP_10:
    ds_read_b32 v18, v4 offset:0
    s_waitcnt lgkmcnt(0)
    v_cmp_le_u32 vcc, 1, v18
    s_add_u32 s68, s68, 1
    s_bitcmp1_b32 s68, 18
    s_cbranch_scc1 SP_ok10
    s_cmp_eq_u64 vcc, exec
    s_cbranch_scc0 SP_10
SP_ok10:
    ds_read_b64 v[10:11], v3 offset:768
    s_waitcnt lgkmcnt(0)
    v_pk_fma_f32 v[92:93], v[92:93], v[10:11], v[158:159] op_sel:[0,1,0] op_sel_hi:[1,1,1]
    v_pk_fma_f32 v[94:95], v[94:95], v[10:11], v[162:163] op_sel:[0,1,0] op_sel_hi:[1,1,1]
    v_pk_fma_f32 v[96:97], v[96:97], v[10:11], v[8:9] op_sel:[0,1,0] op_sel_hi:[1,1,1]
    v_pk_fma_f32 v[98:99], v[98:99], v[10:11], v[106:107] op_sel:[0,1,0] op_sel_hi:[1,1,1]
    v_pk_fma_f32 v[100:101], v[100:101], v[10:11], v[130:131] op_sel:[0,1,0] op_sel_hi:[1,1,1]
    v_pk_fma_f32 v[102:103], v[102:103], v[10:11], v[110:111] op_sel:[0,1,0] op_sel_hi:[1,1,1]
    v_pk_fma_f32 v[92:93], v[156:157], v[10:11], v[92:93] op_sel:[0,0,0] op_sel_hi:[1,0,1]
    v_pk_fma_f32 v[94:95], v[160:161], v[10:11], v[94:95] op_sel:[0,0,0] op_sel_hi:[1,0,1]
    v_pk_fma_f32 v[96:97], v[164:165], v[10:11], v[96:97] op_sel:[0,0,0] op_sel_hi:[1,0,1]
    v_pk_fma_f32 v[98:99], v[104:105], v[10:11], v[98:99] op_sel:[0,0,0] op_sel_hi:[1,0,1]
    v_pk_fma_f32 v[100:101], v[128:129], v[10:11], v[100:101] op_sel:[0,0,0] op_sel_hi:[1,0,1]
    v_pk_fma_f32 v[102:103], v[108:109], v[10:11], v[102:103] op_sel:[0,0,0] op_sel_hi:[1,0,1]
    v_cvt_pk_bf16_f32 v92, v92, v93
    v_cvt_pk_bf16_f32 v93, v94, v95
    v_cvt_pk_bf16_f32 v96, v96, v97
    v_cvt_pk_bf16_f32 v97, v98, v99
    v_cvt_pk_bf16_f32 v100, v100, v101
    v_cvt_pk_bf16_f32 v101, v102, v103
    v_mov_b32 v19, 7
    ds_write_b64 v5, v[92:93] offset:38400
    ds_write_b64 v5, v[96:97] offset:38528
    ds_write_b64 v5, v[100:101] offset:38656
    ds_write_b32 v7, v19 offset:80
    s_branch L_fin2
SP_8:
    ds_read_b32 v8, v6 offset:16
    s_waitcnt lgkmcnt(0)
    v_cmp_le_u32 vcc, s59, v8
    s_add_u32 s68, s68, 1
    s_bitcmp1_b32 s68, 18
    s_cbranch_scc1 SP_ok8
    s_cmp_eq_u64 vcc, exec
    s_cbranch_scc0 SP_8
    s_branch SP_ok8
SP_9:
    ds_read_b32 v8, v6 offset:0
    s_waitcnt lgkmcnt(0)
    v_cmp_le_u32 vcc, s59, v8
    s_add_u32 s68, s68, 1
    s_bitcmp1_b32 s68, 18
    s_cbranch_scc1 SP_ok9
    s_cmp_eq_u64 vcc, exec
    s_cbranch_scc0 SP_9
    s_branch SP_ok9
SP_L:
    ds_read_b32 v18, v4
    s_waitcnt lgkmcnt(0)
    v_cmp_le_u32 vcc, v14, v18
    s_add_u32 s68, s68, 1
    s_bitcmp1_b32 s68, 18
    s_cbranch_scc1 SP_Lok
    s_cmp_eq_u64 vcc, exec
    s_cbranch_scc0 SP_L
    s_branch SP_Lok
L_fin2:
L_fin:
L_end:
    s_endpgm
.section .rodata,"a"
.p2align 6
.amdhsa_kernel standalone__layernorm_linear__sampling_kernel
  .amdhsa_next_free_vgpr 168
  .amdhsa_next_free_sgpr 100
  .amdhsa_accum_offset 168
  .amdhsa_group_segment_fixed_size 0
  .amdhsa_kernarg_size 56
  .amdhsa_user_sgpr_count 2
  .amdhsa_user_sgpr_kernarg_segment_ptr 1
  .amdhsa_system_sgpr_workgroup_id_x 1
.end_amdhsa_kernel
```
